```python
import torch

def _softmax(x, axis=-1):
    return torch.softmax(x, dim=axis)
def _gelu(x):
    return torch.nn.functional.gelu(x, approximate="tanh")
def _silu(x):
    return torch.nn.functional.silu(x)
def _sigmoid(x):
    return torch.sigmoid(x)
def _layernorm(x, axis=-1, eps=1e-5):
    m = x.mean(dim=axis, keepdim=True)
    v = x.var(dim=axis, keepdim=True, unbiased=False)
    return (x - m) / torch.sqrt(v + eps)
def _scatter_add(tgt, idx, src, axis=0):
    return tgt.clone().index_add_(axis, idx, src)
def _segment_sum(src, seg, n):
    out = torch.zeros((n,) + src.shape[1:], dtype=src.dtype)
    return out.index_add_(0, seg, src)
def _pad(x, pw):
    flat = tuple(v for pair in reversed(pw) for v in pair)
    return torch.nn.functional.pad(x, flat)

kernel_name = 'parallel_sum__grouped_kv_mqa__swiglu_ffn__prompt'

def setup_inputs():

    _w = (lambda a: (lambda t: t.to(torch.bfloat16) if t.is_floating_point() else t)(torch.as_tensor(a)))
    def _A_setup():
        B, S, D, H = 1, 2048, 640, 32
        Dh = D // H
        return {
            "x": _w((lambda *s: torch.randn(*s, dtype=torch.bfloat16) * 0.05)(B, S, D)),
            "wq": _w((lambda *s: torch.randn(*s, dtype=torch.bfloat16) * 0.2)(D, H * Dh)),
            "wk": _w((lambda *s: torch.randn(*s, dtype=torch.bfloat16) * 0.2)(D, Dh)),
            "wv": _w((lambda *s: torch.randn(*s, dtype=torch.bfloat16) * 0.1)(D, Dh)),
            "wo": _w((lambda *s: torch.randn(*s, dtype=torch.bfloat16) * 0.1)(H * Dh, D)),
        }
    _A_in = _A_setup()

    def _B_setup():
        B, S, D, F = 1, 2048, 640, 1728
        return {
            "x": _w((lambda *s: torch.randn(*s, dtype=torch.bfloat16) * 0.05)(B, S, D)),
            "w_gate": _w((lambda *s: torch.randn(*s, dtype=torch.bfloat16) * 0.1)(D, F)),
            "w_up": _w((lambda *s: torch.randn(*s, dtype=torch.bfloat16) * 0.1)(D, F)),
            "w_down": _w((lambda *s: torch.randn(*s, dtype=torch.bfloat16) * 0.1)(F, D)),
        }
    _B_in = _B_setup()

    return {
        "A_x": _A_in["x"],
        "A_wq": _A_in["wq"],
        "A_wk": _A_in["wk"],
        "A_wv": _A_in["wv"],
        "A_wo": _A_in["wo"],
        "B_x": _B_in["x"],
        "B_w_gate": _B_in["w_gate"],
        "B_w_up": _B_in["w_up"],
        "B_w_down": _B_in["w_down"],
    }

def reference(A_x, A_wq, A_wk, A_wv, A_wo, B_x, B_w_gate, B_w_up, B_w_down):
    def _A_ref(x, wq, wk, wv, wo):
        B, S, D = x.shape
        H = 32
        Dh = D // H
        q = (lambda x, *d: x.permute(*d))((x @ wq).reshape(B, S, H, Dh), 0, 2, 1, 3)
        k = x @ wk
        v = x @ wv
        scores = torch.einsum("bhqd,bkd->bhqk", q, k) * (Dh ** -0.5)
        p = _softmax(scores, axis=-1)
        o = torch.einsum("bhqk,bkd->bhqd", p, v)
        return (lambda x, *d: x.permute(*d))(o, 0, 2, 1, 3).reshape(B, S, H * Dh) @ wo

    def _B_ref(x, w_gate, w_up, w_down):
        g = _silu(x @ w_gate)
        u = x @ w_up
        return (g * u) @ w_down

    x = A_x
    xn = _layernorm(x, axis=-1)
    return x + _A_ref(xn, A_wq, A_wk, A_wv, A_wo) + _B_ref(xn, B_w_gate, B_w_up, B_w_down)
```

```asm
; @launch kernel=gemm1_kernel grid=(256,1,1) block=(768,1,1) lds=160768
; @launch kernel=k2_kernel grid=(512,1,1) block=(256,1,1) lds=81920
.amdgcn_target "amdgcn-amd-amdhsa--gfx950"
.text
.globl gemm1_kernel
.p2align 8
.type gemm1_kernel,@function
gemm1_kernel:
    s_cmp_ge_u32 s2, 256
    s_cbranch_scc1 k1_exit
    s_load_dwordx4 s[4:7], s[0:1], 0
    s_load_dwordx4 s[8:11], s[0:1], 16
    s_load_dwordx4 s[52:55], s[0:1], 48
    s_load_dwordx4 s[56:59], s[0:1], 80
    v_and_b32 v1, 63, v0
    v_lshrrev_b32 v6, 6, v0
    v_lshlrev_b32 v2, 4, v1
    v_readfirstlane_b32 s14, v6
    s_and_b32 s17, s2, 7
    s_lshr_b32 s18, s2, 3
    s_lshr_b32 s15, s17, 2
    s_lshl_b32 s15, s15, 2
    s_and_b32 s19, s18, 3
    s_add_u32 s15, s15, s19
    s_and_b32 s16, s17, 3
    s_lshl_b32 s16, s16, 3
    s_lshr_b32 s18, s18, 2
    s_add_u32 s16, s16, s18
    s_mov_b32 s18, 0
    s_and_b32 s96, s14, 3
    s_lshr_b32 s97, s14, 2
    v_lshlrev_b32 v6, 2, v1
    s_lshl_b32 s19, s15, 8
    s_lshl_b32 s17, s16, 3
    s_add_u32 s19, s19, s17
    s_add_u32 s48, s19, s14
    s_mul_i32 s19, s48, 1280
    s_waitcnt lgkmcnt(0)
    s_mov_b32 s40, s4
    s_mov_b32 s41, s5
    s_mov_b32 s42, 2621440
    s_mov_b32 s43, 0x00020000
    s_cmp_ge_u32 s14, 8
    s_cbranch_scc1 k1_nosx
    buffer_load_dword v100, v6, s[40:43], s19 offen offset:0
    buffer_load_dword v101, v6, s[40:43], s19 offen offset:256
    buffer_load_dword v102, v6, s[40:43], s19 offen offset:512
    buffer_load_dword v103, v6, s[40:43], s19 offen offset:768
    buffer_load_dword v104, v6, s[40:43], s19 offen offset:1024
k1_nosx:
    s_cmp_lt_u32 s16, 27
    s_cselect_b32 s20, s52, s6
    s_cselect_b32 s21, s53, s7
    s_cselect_b32 s24, s54, s6
    s_cselect_b32 s25, s55, s7
    s_mov_b32 s22, 819200
    s_cselect_b32 s22, 2211840, s22
    s_mov_b32 s26, s22
    s_mov_b32 s23, 0x00020000
    s_mov_b32 s27, 0x00020000
    s_movk_i32 s33, 1280
    s_cselect_b32 s33, 3456, s33
    s_lshl_b32 s28, s16, 7
    s_sub_u32 s17, s16, 27
    s_lshl_b32 s17, s17, 8
    s_cmp_lt_u32 s16, 27
    s_cselect_b32 s28, s28, s17
    s_cselect_b32 s17, 0, 128
    s_lshl_b32 s19, s18, 6
    s_lshl_b32 s29, s14, 3
    s_add_u32 s19, s19, s29
    s_mul_i32 s19, s19, s33
    s_add_u32 s28, s28, s19
    s_add_u32 s29, s28, s17
    s_lshl_b32 s34, s33, 6
    s_mul_i32 s35, s34, -9
    s_and_b32 s17, s16, 1
    s_cmp_eq_u32 s17, 0
    s_cselect_b32 s36, s8, s10
    s_cselect_b32 s37, s9, s11
    s_mov_b32 s38, 25600
    s_mov_b32 s39, 0x00020000
    s_mov_b32 s44, s58
    s_mov_b32 s45, s59
    s_mov_b32 s46, 67108864
    s_mov_b32 s47, 0x00020000
    s_mov_b32 s12, s58
    s_mov_b32 s13, s59
    v_lshrrev_b32 v6, 3, v1
    v_and_b32 v7, 7, v1
    v_lshlrev_b32 v8, 1, v6
    v_and_b32 v8, 4, v8
    v_xor_b32 v8, v7, v8
    v_mul_lo_u32 v3, s33, v6
    v_lshl_add_u32 v3, v8, 4, v3
    v_lshrrev_b32 v8, 4, v1
    v_xor_b32 v8, v7, v8
    v_mul_u32_u24 v9, 1280, v6
    v_lshl_add_u32 v16, v8, 4, v9
    v_xor_b32 v17, 64, v16
    v_add_u32 v17, 10240, v17
    v_add_u32 v18, 20480, v16
    v_add_u32 v19, 20480, v17
    s_cmp_lt_u32 s14, 8
    s_cbranch_scc1 k1_compute
    s_sub_u32 s96, s14, 8
    v_mov_b32 v36, v16
    v_mov_b32 v37, v17
    v_add_u32 v38, 20480, v36
    v_add_u32 v39, 20480, v37
    v_add_u32 v40, 20480, v38
    v_add_u32 v41, 20480, v39
    v_add_u32 v42, 20480, v40
    v_add_u32 v43, 20480, v41
    s_lshl_b32 s19, s14, 3
    s_mul_i32 s19, s19, s33
    s_sub_u32 s28, s28, s19
    s_sub_u32 s29, s29, s19
    s_lshl_b32 s19, s96, 4
    s_mul_i32 s19, s19, s33
    s_add_u32 s28, s28, s19
    s_add_u32 s29, s29, s19
    s_lshl_b32 s19, s33, 3
    s_add_u32 s50, s28, s19
    s_add_u32 s51, s29, s19
    s_lshl_b32 s30, s15, 2
    s_add_u32 s30, s30, s96
    s_mul_i32 s30, s30, 81920
    s_lshl_b32 s17, s18, 7
    s_add_u32 s30, s30, s17
    s_mul_i32 s31, s18, 2560
    s_lshl_b32 s17, s96, 10
    s_add_u32 s31, s31, s17
    s_add_u32 s49, s17, 49152
    s_lshl_b32 s32, s96, 13
    s_lshl_b32 s60, s96, 11
    s_mov_b32 s61, s18
    s_mov_b32 s97, 0
    s_add_u32 s62, s60, s97
    s_add_u32 s63, s32, s97
    s_add_u32 m0, s62, 32768
    s_nop 0
    buffer_load_dwordx4 v3, s[20:23], s28 offen lds
    s_add_u32 m0, s62, 40960
    s_nop 0
    buffer_load_dwordx4 v3, s[24:27], s29 offen lds
    s_add_u32 m0, s62, 33792
    s_nop 0
    buffer_load_dwordx4 v3, s[20:23], s50 offen lds
    s_add_u32 m0, s62, 41984
    s_nop 0
    buffer_load_dwordx4 v3, s[24:27], s51 offen lds
    s_add_u32 m0, s63, 0
    s_nop 0
    buffer_load_dwordx4 v36, s[40:43], s30 offen lds
    s_add_u32 m0, s63, 1024
    s_nop 0
    buffer_load_dwordx4 v37, s[40:43], s30 offen lds
    s_add_u32 m0, s63, 2048
    s_nop 0
    buffer_load_dwordx4 v38, s[40:43], s30 offen lds
    s_add_u32 m0, s63, 3072
    s_nop 0
    buffer_load_dwordx4 v39, s[40:43], s30 offen lds
    s_add_u32 m0, s63, 4096
    s_nop 0
    buffer_load_dwordx4 v40, s[40:43], s30 offen lds
    s_add_u32 m0, s63, 5120
    s_nop 0
    buffer_load_dwordx4 v41, s[40:43], s30 offen lds
    s_add_u32 m0, s63, 6144
    s_nop 0
    buffer_load_dwordx4 v42, s[40:43], s30 offen lds
    s_add_u32 m0, s63, 7168
    s_nop 0
    buffer_load_dwordx4 v43, s[40:43], s30 offen lds
    s_add_u32 m0, s49, s97
    s_nop 0
    buffer_load_dwordx4 v2, s[36:39], s31 offen lds
    s_add_u32 s61, s61, 1
    s_cmp_eq_u32 s61, 10
    s_cselect_b32 s17, s35, s34
    s_movk_i32 s19, 128
    s_cselect_b32 s19, 4294966144, s19
    s_movk_i32 s98, 2560
    s_cselect_b32 s98, 4294944256, s98
    s_cselect_b32 s61, 0, s61
    s_add_u32 s28, s28, s17
    s_add_u32 s29, s29, s17
    s_add_u32 s50, s50, s17
    s_add_u32 s51, s51, s17
    s_add_u32 s30, s30, s19
    s_add_u32 s31, s31, s98
    s_add_u32 s97, s97, 53248
    s_cmp_eq_u32 s97, 159744
    s_cselect_b32 s97, 0, s97
    s_add_u32 s62, s60, s97
    s_add_u32 s63, s32, s97
    s_add_u32 m0, s62, 32768
    s_nop 0
    buffer_load_dwordx4 v3, s[20:23], s28 offen lds
    s_add_u32 m0, s62, 40960
    s_nop 0
    buffer_load_dwordx4 v3, s[24:27], s29 offen lds
    s_add_u32 m0, s62, 33792
    s_nop 0
    buffer_load_dwordx4 v3, s[20:23], s50 offen lds
    s_add_u32 m0, s62, 41984
    s_nop 0
    buffer_load_dwordx4 v3, s[24:27], s51 offen lds
    s_add_u32 m0, s63, 0
    s_nop 0
    buffer_load_dwordx4 v36, s[40:43], s30 offen lds
    s_add_u32 m0, s63, 1024
    s_nop 0
    buffer_load_dwordx4 v37, s[40:43], s30 offen lds
    s_add_u32 m0, s63, 2048
    s_nop 0
    buffer_load_dwordx4 v38, s[40:43], s30 offen lds
    s_add_u32 m0, s63, 3072
    s_nop 0
    buffer_load_dwordx4 v39, s[40:43], s30 offen lds
    s_add_u32 m0, s63, 4096
    s_nop 0
    buffer_load_dwordx4 v40, s[40:43], s30 offen lds
    s_add_u32 m0, s63, 5120
    s_nop 0
    buffer_load_dwordx4 v41, s[40:43], s30 offen lds
    s_add_u32 m0, s63, 6144
    s_nop 0
    buffer_load_dwordx4 v42, s[40:43], s30 offen lds
    s_add_u32 m0, s63, 7168
    s_nop 0
    buffer_load_dwordx4 v43, s[40:43], s30 offen lds
    s_add_u32 m0, s49, s97
    s_nop 0
    buffer_load_dwordx4 v2, s[36:39], s31 offen lds
    s_add_u32 s61, s61, 1
    s_cmp_eq_u32 s61, 10
    s_cselect_b32 s17, s35, s34
    s_movk_i32 s19, 128
    s_cselect_b32 s19, 4294966144, s19
    s_movk_i32 s98, 2560
    s_cselect_b32 s98, 4294944256, s98
    s_cselect_b32 s61, 0, s61
    s_add_u32 s28, s28, s17
    s_add_u32 s29, s29, s17
    s_add_u32 s50, s50, s17
    s_add_u32 s51, s51, s17
    s_add_u32 s30, s30, s19
    s_add_u32 s31, s31, s98
    s_add_u32 s97, s97, 53248
    s_cmp_eq_u32 s97, 159744
    s_cselect_b32 s97, 0, s97
    s_mov_b32 s99, 8
k1_lloop:
    s_waitcnt vmcnt(13)
    s_barrier
    s_add_u32 s62, s60, s97
    s_add_u32 s63, s32, s97
    s_add_u32 m0, s62, 32768
    s_nop 0
    buffer_load_dwordx4 v3, s[20:23], s28 offen lds
    s_add_u32 m0, s62, 40960
    s_nop 0
    buffer_load_dwordx4 v3, s[24:27], s29 offen lds
    s_add_u32 m0, s62, 33792
    s_nop 0
    buffer_load_dwordx4 v3, s[20:23], s50 offen lds
    s_add_u32 m0, s62, 41984
    s_nop 0
    buffer_load_dwordx4 v3, s[24:27], s51 offen lds
    s_add_u32 m0, s63, 0
    s_nop 0
    buffer_load_dwordx4 v36, s[40:43], s30 offen lds
    s_add_u32 m0, s63, 1024
    s_nop 0
    buffer_load_dwordx4 v37, s[40:43], s30 offen lds
    s_add_u32 m0, s63, 2048
    s_nop 0
    buffer_load_dwordx4 v38, s[40:43], s30 offen lds
    s_add_u32 m0, s63, 3072
    s_nop 0
    buffer_load_dwordx4 v39, s[40:43], s30 offen lds
    s_add_u32 m0, s63, 4096
    s_nop 0
    buffer_load_dwordx4 v40, s[40:43], s30 offen lds
    s_add_u32 m0, s63, 5120
    s_nop 0
    buffer_load_dwordx4 v41, s[40:43], s30 offen lds
    s_add_u32 m0, s63, 6144
    s_nop 0
    buffer_load_dwordx4 v42, s[40:43], s30 offen lds
    s_add_u32 m0, s63, 7168
    s_nop 0
    buffer_load_dwordx4 v43, s[40:43], s30 offen lds
    s_add_u32 m0, s49, s97
    s_nop 0
    buffer_load_dwordx4 v2, s[36:39], s31 offen lds
    s_add_u32 s61, s61, 1
    s_cmp_eq_u32 s61, 10
    s_cselect_b32 s17, s35, s34
    s_movk_i32 s19, 128
    s_cselect_b32 s19, 4294966144, s19
    s_movk_i32 s98, 2560
    s_cselect_b32 s98, 4294944256, s98
    s_cselect_b32 s61, 0, s61
    s_add_u32 s28, s28, s17
    s_add_u32 s29, s29, s17
    s_add_u32 s50, s50, s17
    s_add_u32 s51, s51, s17
    s_add_u32 s30, s30, s19
    s_add_u32 s31, s31, s98
    s_add_u32 s97, s97, 53248
    s_cmp_eq_u32 s97, 159744
    s_cselect_b32 s97, 0, s97
    s_sub_u32 s99, s99, 1
    s_cmp_lg_u32 s99, 0
    s_cbranch_scc1 k1_lloop
    s_waitcnt vmcnt(13)
    s_barrier
    s_waitcnt vmcnt(0)
    s_barrier
    s_barrier
    s_endpgm
k1_compute:
    v_lshrrev_b32 v6, 5, v1
    v_bfe_u32 v7, v1, 2, 2
    v_lshl_add_u32 v6, v6, 3, v7
    v_lshlrev_b32 v4, 7, v6
    v_lshrrev_b32 v7, 1, v7
    v_lshl_add_u32 v4, v7, 6, v4
    v_bfe_u32 v7, v1, 4, 1
    v_lshl_add_u32 v4, v7, 5, v4
    v_and_b32 v7, 3, v1
    v_lshl_add_u32 v4, v7, 3, v4
    v_add_u32 v4, 32768, v4
    s_and_b32 s17, s14, 1
    s_lshl_b32 s17, s17, 6
    s_lshr_b32 s19, s96, 1
    s_lshl_b32 s19, s19, 13
    v_xor_b32 v5, s17, v4
    v_add_u32 v5, s19, v5
    s_lshl_b32 s17, s97, 6
    v_xor_b32 v4, s17, v4
    v_and_b32 v6, 31, v1
    v_lshrrev_b32 v7, 5, v1
    v_bfe_u32 v8, v1, 1, 3
    v_xor_b32 v7, v7, v8
    v_lshlrev_b32 v6, 7, v6
    v_lshl_add_u32 v6, v7, 4, v6
    s_lshl_b32 s17, s96, 13
    v_add_u32 v20, s17, v6
    v_xor_b32 v21, 32, v20
    v_xor_b32 v22, 64, v20
    v_xor_b32 v23, 96, v20
    v_and_b32 v13, 15, v1
    v_lshrrev_b32 v14, 4, v1
    s_lshr_b32 s62, s16, 1
    s_lshl_b32 s17, s62, 11
    v_bfe_u32 v8, v13, 1, 3
    v_xor_b32 v8, v14, v8
    v_lshlrev_b32 v11, 7, v13
    v_lshl_add_u32 v11, v8, 4, v11
    v_add_u32 v11, s17, v11
    v_lshrrev_b32 v6, 2, v13
    v_lshl_add_u32 v6, v14, 3, v6
    v_mul_u32_u24 v9, 40, v6
    v_and_b32 v8, 3, v13
    v_lshl_add_u32 v9, v8, 3, v9
    s_and_b32 s17, s14, 1
    s_lshl_b32 s17, s17, 5
    s_add_u32 s17, s17, 49152
    v_add_u32 v9, s17, v9
    s_cmp_eq_u32 s97, 0
    s_cselect_b64 vcc, -1, 0
    v_cndmask_b32 v5, v9, v5, vcc
    s_cmp_lt_u32 s96, 2
    s_cselect_b64 vcc, -1, 0
    s_cselect_b32 s3, 53248, 0
    s_mul_i32 s4, s3, -2
    v_mov_b32 v6, 160256
    v_cndmask_b32 v11, v6, v11, vcc
    v_xor_b32 v12, 64, v11
    v_mov_b32 v144, 0x3f803f80
    v_mov_b32 v145, 0x3f803f80
    v_mov_b32 v146, 0x3f803f80
    v_mov_b32 v147, 0x3f803f80
    v_mov_b64 v[156:157], 0
    v_mov_b64 v[148:149], 0
    v_mov_b64 v[150:151], 0
    s_mov_b32 s63, 0xffff0000
    v_and_b32 v6, 7, v1
    v_lshlrev_b32 v6, 4, v6
    v_add_u32 v6, 160256, v6
    ds_write_b128 v6, v[144:147]
    s_waitcnt vmcnt(0)
    v_lshlrev_b32 v36, 16, v100
    v_and_b32 v37, s63, v100
    v_lshlrev_b32 v38, 16, v101
    v_and_b32 v39, s63, v101
    v_lshlrev_b32 v40, 16, v102
    v_and_b32 v41, s63, v102
    v_lshlrev_b32 v42, 16, v103
    v_and_b32 v43, s63, v103
    v_lshlrev_b32 v44, 16, v104
    v_and_b32 v45, s63, v104
    v_add_f32 v24, v36, v37
    v_add_f32 v24, v24, v38
    v_add_f32 v24, v24, v39
    v_add_f32 v24, v24, v40
    v_add_f32 v24, v24, v41
    v_add_f32 v24, v24, v42
    v_add_f32 v24, v24, v43
    v_add_f32 v24, v24, v44
    v_add_f32 v24, v24, v45
    s_nop 1
    v_add_f32_dpp v24, v24, v24 row_ror:8 row_mask:0xf bank_mask:0xf
    s_nop 1
    v_add_f32_dpp v24, v24, v24 row_ror:4 row_mask:0xf bank_mask:0xf
    s_nop 1
    v_add_f32_dpp v24, v24, v24 row_ror:2 row_mask:0xf bank_mask:0xf
    s_nop 1
    v_add_f32_dpp v24, v24, v24 row_ror:1 row_mask:0xf bank_mask:0xf
    v_mov_b32 v9, v24
    s_nop 1
    v_permlane16_swap_b32 v24, v9
    v_add_f32 v24, v24, v9
    v_mov_b32 v9, v24
    s_nop 1
    v_permlane32_swap_b32 v24, v9
    v_add_f32 v24, v24, v9
    v_mul_f32 v24, 0x3acccccd, v24
    v_sub_f32 v36, v36, v24
    v_sub_f32 v37, v37, v24
    v_sub_f32 v38, v38, v24
    v_sub_f32 v39, v39, v24
    v_sub_f32 v40, v40, v24
    v_sub_f32 v41, v41, v24
    v_sub_f32 v42, v42, v24
    v_sub_f32 v43, v43, v24
    v_sub_f32 v44, v44, v24
    v_sub_f32 v45, v45, v24
    v_mul_f32 v25, v36, v36
    v_fmac_f32 v25, v37, v37
    v_fmac_f32 v25, v38, v38
    v_fmac_f32 v25, v39, v39
    v_fmac_f32 v25, v40, v40
    v_fmac_f32 v25, v41, v41
    v_fmac_f32 v25, v42, v42
    v_fmac_f32 v25, v43, v43
    v_fmac_f32 v25, v44, v44
    v_fmac_f32 v25, v45, v45
    s_nop 1
    v_add_f32_dpp v25, v25, v25 row_ror:8 row_mask:0xf bank_mask:0xf
    s_nop 1
    v_add_f32_dpp v25, v25, v25 row_ror:4 row_mask:0xf bank_mask:0xf
    s_nop 1
    v_add_f32_dpp v25, v25, v25 row_ror:2 row_mask:0xf bank_mask:0xf
    s_nop 1
    v_add_f32_dpp v25, v25, v25 row_ror:1 row_mask:0xf bank_mask:0xf
    v_mov_b32 v9, v25
    s_nop 1
    v_permlane16_swap_b32 v25, v9
    v_add_f32 v25, v25, v9
    v_mov_b32 v9, v25
    s_nop 1
    v_permlane32_swap_b32 v25, v9
    v_add_f32 v25, v25, v9
    v_mov_b32 v9, 0x3727c5ac
    v_fmac_f32 v9, 0x3acccccd, v25
    v_rsq_f32 v25, v9
    s_cmp_lg_u32 s14, 3
    s_cbranch_scc1 k1_nozero
    s_lshl_b32 s17, s2, 7
    s_add_u32 s17, s17, 7372800
    v_lshlrev_b32 v6, 2, v1
    v_mov_b32 v7, 0
    s_mov_b32 exec_hi, 0
    buffer_store_dword v7, v6, s[44:47], s17 offen
    s_mov_b64 exec, -1
k1_nozero:
    v_mov_b32 v6, 0
    s_lshl_b32 s17, s48, 3
    s_add_u32 s17, s17, 7405568
    s_mov_b64 exec, 1
    buffer_store_dwordx2 v[24:25], v6, s[44:47], s17 offen sc1
    s_mov_b64 exec, -1
    s_waitcnt lgkmcnt(0)
    s_barrier
    ds_read_b128 v[100:103], v20 offset:0
    ds_read_b64_tr_b16 v[116:117], v4 offset:0
    ds_read_b64_tr_b16 v[118:119], v4 offset:512
    ds_read_b64_tr_b16 v[120:121], v4 offset:8192
    ds_read_b64_tr_b16 v[122:123], v4 offset:8704
    ds_read_b128 v[104:107], v20 offset:4096
    s_cmp_lg_u32 s97, 0
    s_cbranch_scc1 k1_r0a
    ds_read_b64_tr_b16 v[132:133], v5 offset:0
    ds_read_b64_tr_b16 v[134:135], v5 offset:512
    s_branch k1_r0b
k1_r0a:
    ds_read_b128 v[140:143], v11
    ds_read_b64_tr_b16 v[132:133], v5 offset:0
    ds_read_b64_tr_b16 v[134:135], v5 offset:160
k1_r0b:
    s_waitcnt lgkmcnt(3)
    v_mfma_f32_32x32x16_bf16 v[36:51], v[116:119], v[100:103], 0
    s_cmp_lg_u32 s97, 0
    s_cbranch_scc1 k1_x0a
    s_branch k1_x0b
k1_x0a:
k1_x0b:
    ds_read_b128 v[108:111], v21 offset:0
    ds_read_b64_tr_b16 v[124:125], v4 offset:2048
    s_waitcnt lgkmcnt(3)
    v_mfma_f32_32x32x16_bf16 v[52:67], v[120:123], v[100:103], 0
    ds_read_b64_tr_b16 v[126:127], v4 offset:2560
    ds_read_b64_tr_b16 v[128:129], v4 offset:10240
    s_waitcnt lgkmcnt(4)
    v_mfma_f32_32x32x16_bf16 v[68:83], v[116:119], v[104:107], 0
    ds_read_b64_tr_b16 v[130:131], v4 offset:10752
    ds_read_b128 v[112:115], v21 offset:4096
    v_mfma_f32_32x32x16_bf16 v[84:99], v[120:123], v[104:107], 0
    s_cmp_lg_u32 s97, 0
    s_cbranch_scc1 k1_r1a
    ds_read_b64_tr_b16 v[136:137], v5 offset:2048
    ds_read_b64_tr_b16 v[138:139], v5 offset:2560
k1_r1a:
    s_waitcnt lgkmcnt(3)
    v_mfma_f32_32x32x16_bf16 v[36:51], v[124:127], v[108:111], v[36:51]
    s_cmp_lg_u32 s97, 0
    s_cbranch_scc1 k1_x1a
    v_lshlrev_b32 v28, 16, v132
    v_and_b32 v29, s63, v132
    v_add_f32 v156, v156, v28
    v_add_f32 v157, v157, v29
    v_lshlrev_b32 v28, 16, v133
    v_and_b32 v29, s63, v133
    v_add_f32 v156, v156, v28
    v_add_f32 v157, v157, v29
    v_lshlrev_b32 v28, 16, v134
    v_and_b32 v29, s63, v134
    v_add_f32 v156, v156, v28
    v_add_f32 v157, v157, v29
    v_lshlrev_b32 v28, 16, v135
    v_and_b32 v29, s63, v135
    v_add_f32 v156, v156, v28
    v_add_f32 v157, v157, v29
    s_branch k1_x1b
k1_x1a:
    v_mfma_f32_16x16x32_bf16 v[148:151], v[132:135], v[140:143], v[148:151]
k1_x1b:
    ds_read_b128 v[100:103], v22 offset:0
    ds_read_b64_tr_b16 v[116:117], v4 offset:4096
    s_waitcnt lgkmcnt(3)
    v_mfma_f32_32x32x16_bf16 v[52:67], v[128:131], v[108:111], v[52:67]
    ds_read_b64_tr_b16 v[118:119], v4 offset:4608
    ds_read_b64_tr_b16 v[120:121], v4 offset:12288
    s_waitcnt lgkmcnt(4)
    v_mfma_f32_32x32x16_bf16 v[68:83], v[124:127], v[112:115], v[68:83]
    ds_read_b64_tr_b16 v[122:123], v4 offset:12800
    ds_read_b128 v[104:107], v22 offset:4096
    v_mfma_f32_32x32x16_bf16 v[84:99], v[128:131], v[112:115], v[84:99]
    s_cmp_lg_u32 s97, 0
    s_cbranch_scc1 k1_r2a
    ds_read_b64_tr_b16 v[132:133], v5 offset:4096
    ds_read_b64_tr_b16 v[134:135], v5 offset:4608
    s_branch k1_r2b
k1_r2a:
    ds_read_b128 v[140:143], v12
    ds_read_b64_tr_b16 v[132:133], v5 offset:1280
    ds_read_b64_tr_b16 v[134:135], v5 offset:1440
k1_r2b:
    s_waitcnt lgkmcnt(3)
    v_mfma_f32_32x32x16_bf16 v[36:51], v[116:119], v[100:103], v[36:51]
    s_cmp_lg_u32 s97, 0
    s_cbranch_scc1 k1_x2a
    v_lshlrev_b32 v28, 16, v136
    v_and_b32 v29, s63, v136
    v_add_f32 v156, v156, v28
    v_add_f32 v157, v157, v29
    v_lshlrev_b32 v28, 16, v137
    v_and_b32 v29, s63, v137
    v_add_f32 v156, v156, v28
    v_add_f32 v157, v157, v29
    v_lshlrev_b32 v28, 16, v138
    v_and_b32 v29, s63, v138
    v_add_f32 v156, v156, v28
    v_add_f32 v157, v157, v29
    v_lshlrev_b32 v28, 16, v139
    v_and_b32 v29, s63, v139
    v_add_f32 v156, v156, v28
    v_add_f32 v157, v157, v29
    s_branch k1_x2b
k1_x2a:
k1_x2b:
    ds_read_b128 v[108:111], v23 offset:0
    ds_read_b64_tr_b16 v[124:125], v4 offset:6144
    s_waitcnt lgkmcnt(3)
    v_mfma_f32_32x32x16_bf16 v[52:67], v[120:123], v[100:103], v[52:67]
    ds_read_b64_tr_b16 v[126:127], v4 offset:6656
    ds_read_b64_tr_b16 v[128:129], v4 offset:14336
    s_waitcnt lgkmcnt(4)
    v_mfma_f32_32x32x16_bf16 v[68:83], v[116:119], v[104:107], v[68:83]
    ds_read_b64_tr_b16 v[130:131], v4 offset:14848
    ds_read_b128 v[112:115], v23 offset:4096
    v_mfma_f32_32x32x16_bf16 v[84:99], v[120:123], v[104:107], v[84:99]
    s_cmp_lg_u32 s97, 0
    s_cbranch_scc1 k1_r3a
    ds_read_b64_tr_b16 v[136:137], v5 offset:6144
    ds_read_b64_tr_b16 v[138:139], v5 offset:6656
k1_r3a:
    s_waitcnt lgkmcnt(3)
    v_mfma_f32_32x32x16_bf16 v[36:51], v[124:127], v[108:111], v[36:51]
    s_cmp_lg_u32 s97, 0
    s_cbranch_scc1 k1_x3a
    v_lshlrev_b32 v28, 16, v132
    v_and_b32 v29, s63, v132
    v_add_f32 v156, v156, v28
    v_add_f32 v157, v157, v29
    v_lshlrev_b32 v28, 16, v133
    v_and_b32 v29, s63, v133
    v_add_f32 v156, v156, v28
    v_add_f32 v157, v157, v29
    v_lshlrev_b32 v28, 16, v134
    v_and_b32 v29, s63, v134
    v_add_f32 v156, v156, v28
    v_add_f32 v157, v157, v29
    v_lshlrev_b32 v28, 16, v135
    v_and_b32 v29, s63, v135
    v_add_f32 v156, v156, v28
    v_add_f32 v157, v157, v29
    s_branch k1_x3b
k1_x3a:
    v_mfma_f32_16x16x32_bf16 v[148:151], v[132:135], v[140:143], v[148:151]
k1_x3b:
    s_waitcnt lgkmcnt(1)
    v_mfma_f32_32x32x16_bf16 v[52:67], v[128:131], v[108:111], v[52:67]
    s_waitcnt lgkmcnt(0)
    s_barrier
    v_add_u32 v4, 53248, v4
    v_add_u32 v5, 53248, v5
    v_add_u32 v20, 53248, v20
    v_add_u32 v21, 53248, v21
    v_add_u32 v22, 53248, v22
    v_add_u32 v23, 53248, v23
    v_add_u32 v11, s3, v11
    v_xor_b32 v12, 64, v11
    ds_read_b128 v[100:103], v20 offset:0
    ds_read_b64_tr_b16 v[116:117], v4 offset:0
    ds_read_b64_tr_b16 v[118:119], v4 offset:512
    v_mfma_f32_32x32x16_bf16 v[68:83], v[124:127], v[112:115], v[68:83]
    ds_read_b64_tr_b16 v[120:121], v4 offset:8192
    ds_read_b64_tr_b16 v[122:123], v4 offset:8704
    ds_read_b128 v[104:107], v20 offset:4096
    v_mfma_f32_32x32x16_bf16 v[84:99], v[128:131], v[112:115], v[84:99]
    s_cmp_lg_u32 s97, 0
    s_cbranch_scc1 k1_r4a
    ds_read_b64_tr_b16 v[132:133], v5 offset:0
    ds_read_b64_tr_b16 v[134:135], v5 offset:512
    s_branch k1_r4b
k1_r4a:
    ds_read_b128 v[140:143], v11
    ds_read_b64_tr_b16 v[132:133], v5 offset:0
    ds_read_b64_tr_b16 v[134:135], v5 offset:160
k1_r4b:
    s_waitcnt lgkmcnt(3)
    v_mfma_f32_32x32x16_bf16 v[36:51], v[116:119], v[100:103], v[36:51]
    s_cmp_lg_u32 s97, 0
    s_cbranch_scc1 k1_x4a
    v_lshlrev_b32 v28, 16, v136
    v_and_b32 v29, s63, v136
    v_add_f32 v156, v156, v28
    v_add_f32 v157, v157, v29
    v_lshlrev_b32 v28, 16, v137
    v_and_b32 v29, s63, v137
    v_add_f32 v156, v156, v28
    v_add_f32 v157, v157, v29
    v_lshlrev_b32 v28, 16, v138
    v_and_b32 v29, s63, v138
    v_add_f32 v156, v156, v28
    v_add_f32 v157, v157, v29
    v_lshlrev_b32 v28, 16, v139
    v_and_b32 v29, s63, v139
    v_add_f32 v156, v156, v28
    v_add_f32 v157, v157, v29
    s_branch k1_x4b
k1_x4a:
k1_x4b:
    ds_read_b128 v[108:111], v21 offset:0
    ds_read_b64_tr_b16 v[124:125], v4 offset:2048
    s_waitcnt lgkmcnt(3)
    v_mfma_f32_32x32x16_bf16 v[52:67], v[120:123], v[100:103], v[52:67]
    ds_read_b64_tr_b16 v[126:127], v4 offset:2560
    ds_read_b64_tr_b16 v[128:129], v4 offset:10240
    s_waitcnt lgkmcnt(4)
    v_mfma_f32_32x32x16_bf16 v[68:83], v[116:119], v[104:107], v[68:83]
    ds_read_b64_tr_b16 v[130:131], v4 offset:10752
    ds_read_b128 v[112:115], v21 offset:4096
    v_mfma_f32_32x32x16_bf16 v[84:99], v[120:123], v[104:107], v[84:99]
    s_cmp_lg_u32 s97, 0
    s_cbranch_scc1 k1_r5a
    ds_read_b64_tr_b16 v[136:137], v5 offset:2048
    ds_read_b64_tr_b16 v[138:139], v5 offset:2560
k1_r5a:
    s_waitcnt lgkmcnt(3)
    v_mfma_f32_32x32x16_bf16 v[36:51], v[124:127], v[108:111], v[36:51]
    s_cmp_lg_u32 s97, 0
    s_cbranch_scc1 k1_x5a
    v_lshlrev_b32 v28, 16, v132
    v_and_b32 v29, s63, v132
    v_add_f32 v156, v156, v28
    v_add_f32 v157, v157, v29
    v_lshlrev_b32 v28, 16, v133
    v_and_b32 v29, s63, v133
    v_add_f32 v156, v156, v28
    v_add_f32 v157, v157, v29
    v_lshlrev_b32 v28, 16, v134
    v_and_b32 v29, s63, v134
    v_add_f32 v156, v156, v28
    v_add_f32 v157, v157, v29
    v_lshlrev_b32 v28, 16, v135
    v_and_b32 v29, s63, v135
    v_add_f32 v156, v156, v28
    v_add_f32 v157, v157, v29
    s_branch k1_x5b
k1_x5a:
    v_mfma_f32_16x16x32_bf16 v[148:151], v[132:135], v[140:143], v[148:151]
k1_x5b:
    ds_read_b128 v[100:103], v22 offset:0
    ds_read_b64_tr_b16 v[116:117], v4 offset:4096
    s_waitcnt lgkmcnt(3)
    v_mfma_f32_32x32x16_bf16 v[52:67], v[128:131], v[108:111], v[52:67]
    ds_read_b64_tr_b16 v[118:119], v4 offset:4608
    ds_read_b64_tr_b16 v[120:121], v4 offset:12288
    s_waitcnt lgkmcnt(4)
    v_mfma_f32_32x32x16_bf16 v[68:83], v[124:127], v[112:115], v[68:83]
    ds_read_b64_tr_b16 v[122:123], v4 offset:12800
    ds_read_b128 v[104:107], v22 offset:4096
    v_mfma_f32_32x32x16_bf16 v[84:99], v[128:131], v[112:115], v[84:99]
    s_cmp_lg_u32 s97, 0
    s_cbranch_scc1 k1_r6a
    ds_read_b64_tr_b16 v[132:133], v5 offset:4096
    ds_read_b64_tr_b16 v[134:135], v5 offset:4608
    s_branch k1_r6b
k1_r6a:
    ds_read_b128 v[140:143], v12
    ds_read_b64_tr_b16 v[132:133], v5 offset:1280
    ds_read_b64_tr_b16 v[134:135], v5 offset:1440
k1_r6b:
    s_waitcnt lgkmcnt(3)
    v_mfma_f32_32x32x16_bf16 v[36:51], v[116:119], v[100:103], v[36:51]
    s_cmp_lg_u32 s97, 0
    s_cbranch_scc1 k1_x6a
    v_lshlrev_b32 v28, 16, v136
    v_and_b32 v29, s63, v136
    v_add_f32 v156, v156, v28
    v_add_f32 v157, v157, v29
    v_lshlrev_b32 v28, 16, v137
    v_and_b32 v29, s63, v137
    v_add_f32 v156, v156, v28
    v_add_f32 v157, v157, v29
    v_lshlrev_b32 v28, 16, v138
    v_and_b32 v29, s63, v138
    v_add_f32 v156, v156, v28
    v_add_f32 v157, v157, v29
    v_lshlrev_b32 v28, 16, v139
    v_and_b32 v29, s63, v139
    v_add_f32 v156, v156, v28
    v_add_f32 v157, v157, v29
    s_branch k1_x6b
k1_x6a:
k1_x6b:
    ds_read_b128 v[108:111], v23 offset:0
    ds_read_b64_tr_b16 v[124:125], v4 offset:6144
    s_waitcnt lgkmcnt(3)
    v_mfma_f32_32x32x16_bf16 v[52:67], v[120:123], v[100:103], v[52:67]
    ds_read_b64_tr_b16 v[126:127], v4 offset:6656
    ds_read_b64_tr_b16 v[128:129], v4 offset:14336
    s_waitcnt lgkmcnt(4)
    v_mfma_f32_32x32x16_bf16 v[68:83], v[116:119], v[104:107], v[68:83]
    ds_read_b64_tr_b16 v[130:131], v4 offset:14848
    ds_read_b128 v[112:115], v23 offset:4096
    v_mfma_f32_32x32x16_bf16 v[84:99], v[120:123], v[104:107], v[84:99]
    s_cmp_lg_u32 s97, 0
    s_cbranch_scc1 k1_r7a
    ds_read_b64_tr_b16 v[136:137], v5 offset:6144
    ds_read_b64_tr_b16 v[138:139], v5 offset:6656
k1_r7a:
    s_waitcnt lgkmcnt(3)
    v_mfma_f32_32x32x16_bf16 v[36:51], v[124:127], v[108:111], v[36:51]
    s_cmp_lg_u32 s97, 0
    s_cbranch_scc1 k1_x7a
    v_lshlrev_b32 v28, 16, v132
    v_and_b32 v29, s63, v132
    v_add_f32 v156, v156, v28
    v_add_f32 v157, v157, v29
    v_lshlrev_b32 v28, 16, v133
    v_and_b32 v29, s63, v133
    v_add_f32 v156, v156, v28
    v_add_f32 v157, v157, v29
    v_lshlrev_b32 v28, 16, v134
    v_and_b32 v29, s63, v134
    v_add_f32 v156, v156, v28
    v_add_f32 v157, v157, v29
    v_lshlrev_b32 v28, 16, v135
    v_and_b32 v29, s63, v135
    v_add_f32 v156, v156, v28
    v_add_f32 v157, v157, v29
    s_branch k1_x7b
k1_x7a:
    v_mfma_f32_16x16x32_bf16 v[148:151], v[132:135], v[140:143], v[148:151]
k1_x7b:
    s_waitcnt lgkmcnt(1)
    v_mfma_f32_32x32x16_bf16 v[52:67], v[128:131], v[108:111], v[52:67]
    s_waitcnt lgkmcnt(0)
    s_waitcnt vmcnt(0)
    s_barrier
    s_cmp_lg_u32 s14, 0
    s_cbranch_scc1 k1_nofl
    s_lshl_b32 s17, s15, 5
    v_mov_b32 v6, s17
    v_mov_b32 v7, 1
    s_mov_b64 exec, 1
    global_atomic_add v6, v7, s[56:57]
    s_mov_b64 exec, -1
k1_nofl:
    v_add_u32 v4, 53248, v4
    v_add_u32 v5, 53248, v5
    v_add_u32 v20, 53248, v20
    v_add_u32 v21, 53248, v21
    v_add_u32 v22, 53248, v22
    v_add_u32 v23, 53248, v23
    v_add_u32 v11, s3, v11
    v_xor_b32 v12, 64, v11
    ds_read_b128 v[100:103], v20 offset:0
    ds_read_b64_tr_b16 v[116:117], v4 offset:0
    ds_read_b64_tr_b16 v[118:119], v4 offset:512
    v_mfma_f32_32x32x16_bf16 v[68:83], v[124:127], v[112:115], v[68:83]
    ds_read_b64_tr_b16 v[120:121], v4 offset:8192
    ds_read_b64_tr_b16 v[122:123], v4 offset:8704
    ds_read_b128 v[104:107], v20 offset:4096
    v_mfma_f32_32x32x16_bf16 v[84:99], v[128:131], v[112:115], v[84:99]
    s_cmp_lg_u32 s97, 0
    s_cbranch_scc1 k1_r8a
    ds_read_b64_tr_b16 v[132:133], v5 offset:0
    ds_read_b64_tr_b16 v[134:135], v5 offset:512
    s_branch k1_r8b
k1_r8a:
    ds_read_b128 v[140:143], v11
    ds_read_b64_tr_b16 v[132:133], v5 offset:0
    ds_read_b64_tr_b16 v[134:135], v5 offset:160
k1_r8b:
    s_waitcnt lgkmcnt(3)
    v_mfma_f32_32x32x16_bf16 v[36:51], v[116:119], v[100:103], v[36:51]
    s_cmp_lg_u32 s97, 0
    s_cbranch_scc1 k1_x8a
    v_lshlrev_b32 v28, 16, v136
    v_and_b32 v29, s63, v136
    v_add_f32 v156, v156, v28
    v_add_f32 v157, v157, v29
    v_lshlrev_b32 v28, 16, v137
    v_and_b32 v29, s63, v137
    v_add_f32 v156, v156, v28
    v_add_f32 v157, v157, v29
    v_lshlrev_b32 v28, 16, v138
    v_and_b32 v29, s63, v138
    v_add_f32 v156, v156, v28
    v_add_f32 v157, v157, v29
    v_lshlrev_b32 v28, 16, v139
    v_and_b32 v29, s63, v139
    v_add_f32 v156, v156, v28
    v_add_f32 v157, v157, v29
    s_branch k1_x8b
k1_x8a:
k1_x8b:
    ds_read_b128 v[108:111], v21 offset:0
    ds_read_b64_tr_b16 v[124:125], v4 offset:2048
    s_waitcnt lgkmcnt(3)
    v_mfma_f32_32x32x16_bf16 v[52:67], v[120:123], v[100:103], v[52:67]
    ds_read_b64_tr_b16 v[126:127], v4 offset:2560
    ds_read_b64_tr_b16 v[128:129], v4 offset:10240
    s_waitcnt lgkmcnt(4)
    v_mfma_f32_32x32x16_bf16 v[68:83], v[116:119], v[104:107], v[68:83]
    ds_read_b64_tr_b16 v[130:131], v4 offset:10752
    ds_read_b128 v[112:115], v21 offset:4096
    v_mfma_f32_32x32x16_bf16 v[84:99], v[120:123], v[104:107], v[84:99]
    s_cmp_lg_u32 s97, 0
    s_cbranch_scc1 k1_r9a
    ds_read_b64_tr_b16 v[136:137], v5 offset:2048
    ds_read_b64_tr_b16 v[138:139], v5 offset:2560
k1_r9a:
    s_waitcnt lgkmcnt(3)
    v_mfma_f32_32x32x16_bf16 v[36:51], v[124:127], v[108:111], v[36:51]
    s_cmp_lg_u32 s97, 0
    s_cbranch_scc1 k1_x9a
    v_lshlrev_b32 v28, 16, v132
    v_and_b32 v29, s63, v132
    v_add_f32 v156, v156, v28
    v_add_f32 v157, v157, v29
    v_lshlrev_b32 v28, 16, v133
    v_and_b32 v29, s63, v133
    v_add_f32 v156, v156, v28
    v_add_f32 v157, v157, v29
    v_lshlrev_b32 v28, 16, v134
    v_and_b32 v29, s63, v134
    v_add_f32 v156, v156, v28
    v_add_f32 v157, v157, v29
    v_lshlrev_b32 v28, 16, v135
    v_and_b32 v29, s63, v135
    v_add_f32 v156, v156, v28
    v_add_f32 v157, v157, v29
    s_branch k1_x9b
k1_x9a:
    v_mfma_f32_16x16x32_bf16 v[148:151], v[132:135], v[140:143], v[148:151]
k1_x9b:
    ds_read_b128 v[100:103], v22 offset:0
    ds_read_b64_tr_b16 v[116:117], v4 offset:4096
    s_waitcnt lgkmcnt(3)
    v_mfma_f32_32x32x16_bf16 v[52:67], v[128:131], v[108:111], v[52:67]
    ds_read_b64_tr_b16 v[118:119], v4 offset:4608
    ds_read_b64_tr_b16 v[120:121], v4 offset:12288
    s_waitcnt lgkmcnt(4)
    v_mfma_f32_32x32x16_bf16 v[68:83], v[124:127], v[112:115], v[68:83]
    ds_read_b64_tr_b16 v[122:123], v4 offset:12800
    ds_read_b128 v[104:107], v22 offset:4096
    v_mfma_f32_32x32x16_bf16 v[84:99], v[128:131], v[112:115], v[84:99]
    s_cmp_lg_u32 s97, 0
    s_cbranch_scc1 k1_r10a
    ds_read_b64_tr_b16 v[132:133], v5 offset:4096
    ds_read_b64_tr_b16 v[134:135], v5 offset:4608
    s_branch k1_r10b
k1_r10a:
    ds_read_b128 v[140:143], v12
    ds_read_b64_tr_b16 v[132:133], v5 offset:1280
    ds_read_b64_tr_b16 v[134:135], v5 offset:1440
k1_r10b:
    s_waitcnt lgkmcnt(3)
    v_mfma_f32_32x32x16_bf16 v[36:51], v[116:119], v[100:103], v[36:51]
    s_cmp_lg_u32 s97, 0
    s_cbranch_scc1 k1_x10a
    v_lshlrev_b32 v28, 16, v136
    v_and_b32 v29, s63, v136
    v_add_f32 v156, v156, v28
    v_add_f32 v157, v157, v29
    v_lshlrev_b32 v28, 16, v137
    v_and_b32 v29, s63, v137
    v_add_f32 v156, v156, v28
    v_add_f32 v157, v157, v29
    v_lshlrev_b32 v28, 16, v138
    v_and_b32 v29, s63, v138
    v_add_f32 v156, v156, v28
    v_add_f32 v157, v157, v29
    v_lshlrev_b32 v28, 16, v139
    v_and_b32 v29, s63, v139
    v_add_f32 v156, v156, v28
    v_add_f32 v157, v157, v29
    s_branch k1_x10b
k1_x10a:
k1_x10b:
    ds_read_b128 v[108:111], v23 offset:0
    ds_read_b64_tr_b16 v[124:125], v4 offset:6144
    s_waitcnt lgkmcnt(3)
    v_mfma_f32_32x32x16_bf16 v[52:67], v[120:123], v[100:103], v[52:67]
    ds_read_b64_tr_b16 v[126:127], v4 offset:6656
    ds_read_b64_tr_b16 v[128:129], v4 offset:14336
    s_waitcnt lgkmcnt(4)
    v_mfma_f32_32x32x16_bf16 v[68:83], v[116:119], v[104:107], v[68:83]
    ds_read_b64_tr_b16 v[130:131], v4 offset:14848
    ds_read_b128 v[112:115], v23 offset:4096
    v_mfma_f32_32x32x16_bf16 v[84:99], v[120:123], v[104:107], v[84:99]
    s_cmp_lg_u32 s97, 0
    s_cbranch_scc1 k1_r11a
    ds_read_b64_tr_b16 v[136:137], v5 offset:6144
    ds_read_b64_tr_b16 v[138:139], v5 offset:6656
k1_r11a:
    s_waitcnt lgkmcnt(3)
    v_mfma_f32_32x32x16_bf16 v[36:51], v[124:127], v[108:111], v[36:51]
    s_cmp_lg_u32 s97, 0
    s_cbranch_scc1 k1_x11a
    v_lshlrev_b32 v28, 16, v132
    v_and_b32 v29, s63, v132
    v_add_f32 v156, v156, v28
    v_add_f32 v157, v157, v29
    v_lshlrev_b32 v28, 16, v133
    v_and_b32 v29, s63, v133
    v_add_f32 v156, v156, v28
    v_add_f32 v157, v157, v29
    v_lshlrev_b32 v28, 16, v134
    v_and_b32 v29, s63, v134
    v_add_f32 v156, v156, v28
    v_add_f32 v157, v157, v29
    v_lshlrev_b32 v28, 16, v135
    v_and_b32 v29, s63, v135
    v_add_f32 v156, v156, v28
    v_add_f32 v157, v157, v29
    s_branch k1_x11b
k1_x11a:
    v_mfma_f32_16x16x32_bf16 v[148:151], v[132:135], v[140:143], v[148:151]
k1_x11b:
    s_waitcnt lgkmcnt(1)
    v_mfma_f32_32x32x16_bf16 v[52:67], v[128:131], v[108:111], v[52:67]
    s_waitcnt lgkmcnt(0)
    s_barrier
    v_add_u32 v4, 4294860800, v4
    v_add_u32 v5, 4294860800, v5
    v_add_u32 v20, 4294860800, v20
    v_add_u32 v21, 4294860800, v21
    v_add_u32 v22, 4294860800, v22
    v_add_u32 v23, 4294860800, v23
    v_add_u32 v11, s4, v11
    v_xor_b32 v12, 64, v11
    ds_read_b128 v[100:103], v20 offset:0
    ds_read_b64_tr_b16 v[116:117], v4 offset:0
    ds_read_b64_tr_b16 v[118:119], v4 offset:512
    v_mfma_f32_32x32x16_bf16 v[68:83], v[124:127], v[112:115], v[68:83]
    ds_read_b64_tr_b16 v[120:121], v4 offset:8192
    ds_read_b64_tr_b16 v[122:123], v4 offset:8704
    ds_read_b128 v[104:107], v20 offset:4096
    v_mfma_f32_32x32x16_bf16 v[84:99], v[128:131], v[112:115], v[84:99]
    s_cmp_lg_u32 s97, 0
    s_cbranch_scc1 k1_r12a
    ds_read_b64_tr_b16 v[132:133], v5 offset:0
    ds_read_b64_tr_b16 v[134:135], v5 offset:512
    s_branch k1_r12b
k1_r12a:
    ds_read_b128 v[140:143], v11
    ds_read_b64_tr_b16 v[132:133], v5 offset:0
    ds_read_b64_tr_b16 v[134:135], v5 offset:160
k1_r12b:
    s_waitcnt lgkmcnt(3)
    v_mfma_f32_32x32x16_bf16 v[36:51], v[116:119], v[100:103], v[36:51]
    s_cmp_lg_u32 s97, 0
    s_cbranch_scc1 k1_x12a
    v_lshlrev_b32 v28, 16, v136
    v_and_b32 v29, s63, v136
    v_add_f32 v156, v156, v28
    v_add_f32 v157, v157, v29
    v_lshlrev_b32 v28, 16, v137
    v_and_b32 v29, s63, v137
    v_add_f32 v156, v156, v28
    v_add_f32 v157, v157, v29
    v_lshlrev_b32 v28, 16, v138
    v_and_b32 v29, s63, v138
    v_add_f32 v156, v156, v28
    v_add_f32 v157, v157, v29
    v_lshlrev_b32 v28, 16, v139
    v_and_b32 v29, s63, v139
    v_add_f32 v156, v156, v28
    v_add_f32 v157, v157, v29
    s_branch k1_x12b
k1_x12a:
k1_x12b:
    ds_read_b128 v[108:111], v21 offset:0
    ds_read_b64_tr_b16 v[124:125], v4 offset:2048
    s_waitcnt lgkmcnt(3)
    v_mfma_f32_32x32x16_bf16 v[52:67], v[120:123], v[100:103], v[52:67]
    ds_read_b64_tr_b16 v[126:127], v4 offset:2560
    ds_read_b64_tr_b16 v[128:129], v4 offset:10240
    s_waitcnt lgkmcnt(4)
    v_mfma_f32_32x32x16_bf16 v[68:83], v[116:119], v[104:107], v[68:83]
    ds_read_b64_tr_b16 v[130:131], v4 offset:10752
    ds_read_b128 v[112:115], v21 offset:4096
    v_mfma_f32_32x32x16_bf16 v[84:99], v[120:123], v[104:107], v[84:99]
    s_cmp_lg_u32 s97, 0
    s_cbranch_scc1 k1_r13a
    ds_read_b64_tr_b16 v[136:137], v5 offset:2048
    ds_read_b64_tr_b16 v[138:139], v5 offset:2560
k1_r13a:
    s_waitcnt lgkmcnt(3)
    v_mfma_f32_32x32x16_bf16 v[36:51], v[124:127], v[108:111], v[36:51]
    s_cmp_lg_u32 s97, 0
    s_cbranch_scc1 k1_x13a
    v_lshlrev_b32 v28, 16, v132
    v_and_b32 v29, s63, v132
    v_add_f32 v156, v156, v28
    v_add_f32 v157, v157, v29
    v_lshlrev_b32 v28, 16, v133
    v_and_b32 v29, s63, v133
    v_add_f32 v156, v156, v28
    v_add_f32 v157, v157, v29
    v_lshlrev_b32 v28, 16, v134
    v_and_b32 v29, s63, v134
    v_add_f32 v156, v156, v28
    v_add_f32 v157, v157, v29
    v_lshlrev_b32 v28, 16, v135
    v_and_b32 v29, s63, v135
    v_add_f32 v156, v156, v28
    v_add_f32 v157, v157, v29
    s_branch k1_x13b
k1_x13a:
    v_mfma_f32_16x16x32_bf16 v[148:151], v[132:135], v[140:143], v[148:151]
k1_x13b:
    ds_read_b128 v[100:103], v22 offset:0
    ds_read_b64_tr_b16 v[116:117], v4 offset:4096
    s_waitcnt lgkmcnt(3)
    v_mfma_f32_32x32x16_bf16 v[52:67], v[128:131], v[108:111], v[52:67]
    ds_read_b64_tr_b16 v[118:119], v4 offset:4608
    ds_read_b64_tr_b16 v[120:121], v4 offset:12288
    s_waitcnt lgkmcnt(4)
    v_mfma_f32_32x32x16_bf16 v[68:83], v[124:127], v[112:115], v[68:83]
    ds_read_b64_tr_b16 v[122:123], v4 offset:12800
    ds_read_b128 v[104:107], v22 offset:4096
    v_mfma_f32_32x32x16_bf16 v[84:99], v[128:131], v[112:115], v[84:99]
    s_cmp_lg_u32 s97, 0
    s_cbranch_scc1 k1_r14a
    ds_read_b64_tr_b16 v[132:133], v5 offset:4096
    ds_read_b64_tr_b16 v[134:135], v5 offset:4608
    s_branch k1_r14b
k1_r14a:
    ds_read_b128 v[140:143], v12
    ds_read_b64_tr_b16 v[132:133], v5 offset:1280
    ds_read_b64_tr_b16 v[134:135], v5 offset:1440
k1_r14b:
    s_waitcnt lgkmcnt(3)
    v_mfma_f32_32x32x16_bf16 v[36:51], v[116:119], v[100:103], v[36:51]
    s_cmp_lg_u32 s97, 0
    s_cbranch_scc1 k1_x14a
    v_lshlrev_b32 v28, 16, v136
    v_and_b32 v29, s63, v136
    v_add_f32 v156, v156, v28
    v_add_f32 v157, v157, v29
    v_lshlrev_b32 v28, 16, v137
    v_and_b32 v29, s63, v137
    v_add_f32 v156, v156, v28
    v_add_f32 v157, v157, v29
    v_lshlrev_b32 v28, 16, v138
    v_and_b32 v29, s63, v138
    v_add_f32 v156, v156, v28
    v_add_f32 v157, v157, v29
    v_lshlrev_b32 v28, 16, v139
    v_and_b32 v29, s63, v139
    v_add_f32 v156, v156, v28
    v_add_f32 v157, v157, v29
    s_branch k1_x14b
k1_x14a:
k1_x14b:
    ds_read_b128 v[108:111], v23 offset:0
    ds_read_b64_tr_b16 v[124:125], v4 offset:6144
    s_waitcnt lgkmcnt(3)
    v_mfma_f32_32x32x16_bf16 v[52:67], v[120:123], v[100:103], v[52:67]
    ds_read_b64_tr_b16 v[126:127], v4 offset:6656
    ds_read_b64_tr_b16 v[128:129], v4 offset:14336
    s_waitcnt lgkmcnt(4)
    v_mfma_f32_32x32x16_bf16 v[68:83], v[116:119], v[104:107], v[68:83]
    ds_read_b64_tr_b16 v[130:131], v4 offset:14848
    ds_read_b128 v[112:115], v23 offset:4096
    v_mfma_f32_32x32x16_bf16 v[84:99], v[120:123], v[104:107], v[84:99]
    s_cmp_lg_u32 s97, 0
    s_cbranch_scc1 k1_r15a
    ds_read_b64_tr_b16 v[136:137], v5 offset:6144
    ds_read_b64_tr_b16 v[138:139], v5 offset:6656
k1_r15a:
    s_waitcnt lgkmcnt(3)
    v_mfma_f32_32x32x16_bf16 v[36:51], v[124:127], v[108:111], v[36:51]
    s_cmp_lg_u32 s97, 0
    s_cbranch_scc1 k1_x15a
    v_lshlrev_b32 v28, 16, v132
    v_and_b32 v29, s63, v132
    v_add_f32 v156, v156, v28
    v_add_f32 v157, v157, v29
    v_lshlrev_b32 v28, 16, v133
    v_and_b32 v29, s63, v133
    v_add_f32 v156, v156, v28
    v_add_f32 v157, v157, v29
    v_lshlrev_b32 v28, 16, v134
    v_and_b32 v29, s63, v134
    v_add_f32 v156, v156, v28
    v_add_f32 v157, v157, v29
    v_lshlrev_b32 v28, 16, v135
    v_and_b32 v29, s63, v135
    v_add_f32 v156, v156, v28
    v_add_f32 v157, v157, v29
    s_branch k1_x15b
k1_x15a:
    v_mfma_f32_16x16x32_bf16 v[148:151], v[132:135], v[140:143], v[148:151]
k1_x15b:
    s_waitcnt lgkmcnt(1)
    v_mfma_f32_32x32x16_bf16 v[52:67], v[128:131], v[108:111], v[52:67]
    s_waitcnt lgkmcnt(0)
    s_barrier
    v_add_u32 v4, 53248, v4
    v_add_u32 v5, 53248, v5
    v_add_u32 v20, 53248, v20
    v_add_u32 v21, 53248, v21
    v_add_u32 v22, 53248, v22
    v_add_u32 v23, 53248, v23
    v_add_u32 v11, s3, v11
    v_xor_b32 v12, 64, v11
    ds_read_b128 v[100:103], v20 offset:0
    ds_read_b64_tr_b16 v[116:117], v4 offset:0
    ds_read_b64_tr_b16 v[118:119], v4 offset:512
    v_mfma_f32_32x32x16_bf16 v[68:83], v[124:127], v[112:115], v[68:83]
    ds_read_b64_tr_b16 v[120:121], v4 offset:8192
    ds_read_b64_tr_b16 v[122:123], v4 offset:8704
    ds_read_b128 v[104:107], v20 offset:4096
    v_mfma_f32_32x32x16_bf16 v[84:99], v[128:131], v[112:115], v[84:99]
    s_cmp_lg_u32 s97, 0
    s_cbranch_scc1 k1_r16a
    ds_read_b64_tr_b16 v[132:133], v5 offset:0
    ds_read_b64_tr_b16 v[134:135], v5 offset:512
    s_branch k1_r16b
k1_r16a:
    ds_read_b128 v[140:143], v11
    ds_read_b64_tr_b16 v[132:133], v5 offset:0
    ds_read_b64_tr_b16 v[134:135], v5 offset:160
k1_r16b:
    s_waitcnt lgkmcnt(3)
    v_mfma_f32_32x32x16_bf16 v[36:51], v[116:119], v[100:103], v[36:51]
    s_cmp_lg_u32 s97, 0
    s_cbranch_scc1 k1_x16a
    v_lshlrev_b32 v28, 16, v136
    v_and_b32 v29, s63, v136
    v_add_f32 v156, v156, v28
    v_add_f32 v157, v157, v29
    v_lshlrev_b32 v28, 16, v137
    v_and_b32 v29, s63, v137
    v_add_f32 v156, v156, v28
    v_add_f32 v157, v157, v29
    v_lshlrev_b32 v28, 16, v138
    v_and_b32 v29, s63, v138
    v_add_f32 v156, v156, v28
    v_add_f32 v157, v157, v29
    v_lshlrev_b32 v28, 16, v139
    v_and_b32 v29, s63, v139
    v_add_f32 v156, v156, v28
    v_add_f32 v157, v157, v29
    s_branch k1_x16b
k1_x16a:
k1_x16b:
    ds_read_b128 v[108:111], v21 offset:0
    ds_read_b64_tr_b16 v[124:125], v4 offset:2048
    s_waitcnt lgkmcnt(3)
    v_mfma_f32_32x32x16_bf16 v[52:67], v[120:123], v[100:103], v[52:67]
    ds_read_b64_tr_b16 v[126:127], v4 offset:2560
    ds_read_b64_tr_b16 v[128:129], v4 offset:10240
    s_waitcnt lgkmcnt(4)
    v_mfma_f32_32x32x16_bf16 v[68:83], v[116:119], v[104:107], v[68:83]
    ds_read_b64_tr_b16 v[130:131], v4 offset:10752
    ds_read_b128 v[112:115], v21 offset:4096
    v_mfma_f32_32x32x16_bf16 v[84:99], v[120:123], v[104:107], v[84:99]
    s_cmp_lg_u32 s97, 0
    s_cbranch_scc1 k1_r17a
    ds_read_b64_tr_b16 v[136:137], v5 offset:2048
    ds_read_b64_tr_b16 v[138:139], v5 offset:2560
k1_r17a:
    s_waitcnt lgkmcnt(3)
    v_mfma_f32_32x32x16_bf16 v[36:51], v[124:127], v[108:111], v[36:51]
    s_cmp_lg_u32 s97, 0
    s_cbranch_scc1 k1_x17a
    v_lshlrev_b32 v28, 16, v132
    v_and_b32 v29, s63, v132
    v_add_f32 v156, v156, v28
    v_add_f32 v157, v157, v29
    v_lshlrev_b32 v28, 16, v133
    v_and_b32 v29, s63, v133
    v_add_f32 v156, v156, v28
    v_add_f32 v157, v157, v29
    v_lshlrev_b32 v28, 16, v134
    v_and_b32 v29, s63, v134
    v_add_f32 v156, v156, v28
    v_add_f32 v157, v157, v29
    v_lshlrev_b32 v28, 16, v135
    v_and_b32 v29, s63, v135
    v_add_f32 v156, v156, v28
    v_add_f32 v157, v157, v29
    s_branch k1_x17b
k1_x17a:
    v_mfma_f32_16x16x32_bf16 v[148:151], v[132:135], v[140:143], v[148:151]
k1_x17b:
    ds_read_b128 v[100:103], v22 offset:0
    ds_read_b64_tr_b16 v[116:117], v4 offset:4096
    s_waitcnt lgkmcnt(3)
    v_mfma_f32_32x32x16_bf16 v[52:67], v[128:131], v[108:111], v[52:67]
    ds_read_b64_tr_b16 v[118:119], v4 offset:4608
    ds_read_b64_tr_b16 v[120:121], v4 offset:12288
    s_waitcnt lgkmcnt(4)
    v_mfma_f32_32x32x16_bf16 v[68:83], v[124:127], v[112:115], v[68:83]
    ds_read_b64_tr_b16 v[122:123], v4 offset:12800
    ds_read_b128 v[104:107], v22 offset:4096
    v_mfma_f32_32x32x16_bf16 v[84:99], v[128:131], v[112:115], v[84:99]
    s_cmp_lg_u32 s97, 0
    s_cbranch_scc1 k1_r18a
    ds_read_b64_tr_b16 v[132:133], v5 offset:4096
    ds_read_b64_tr_b16 v[134:135], v5 offset:4608
    s_branch k1_r18b
k1_r18a:
    ds_read_b128 v[140:143], v12
    ds_read_b64_tr_b16 v[132:133], v5 offset:1280
    ds_read_b64_tr_b16 v[134:135], v5 offset:1440
k1_r18b:
    s_waitcnt lgkmcnt(3)
    v_mfma_f32_32x32x16_bf16 v[36:51], v[116:119], v[100:103], v[36:51]
    s_cmp_lg_u32 s97, 0
    s_cbranch_scc1 k1_x18a
    v_lshlrev_b32 v28, 16, v136
    v_and_b32 v29, s63, v136
    v_add_f32 v156, v156, v28
    v_add_f32 v157, v157, v29
    v_lshlrev_b32 v28, 16, v137
    v_and_b32 v29, s63, v137
    v_add_f32 v156, v156, v28
    v_add_f32 v157, v157, v29
    v_lshlrev_b32 v28, 16, v138
    v_and_b32 v29, s63, v138
    v_add_f32 v156, v156, v28
    v_add_f32 v157, v157, v29
    v_lshlrev_b32 v28, 16, v139
    v_and_b32 v29, s63, v139
    v_add_f32 v156, v156, v28
    v_add_f32 v157, v157, v29
    s_branch k1_x18b
k1_x18a:
k1_x18b:
    ds_read_b128 v[108:111], v23 offset:0
    ds_read_b64_tr_b16 v[124:125], v4 offset:6144
    s_waitcnt lgkmcnt(3)
    v_mfma_f32_32x32x16_bf16 v[52:67], v[120:123], v[100:103], v[52:67]
    ds_read_b64_tr_b16 v[126:127], v4 offset:6656
    ds_read_b64_tr_b16 v[128:129], v4 offset:14336
    s_waitcnt lgkmcnt(4)
    v_mfma_f32_32x32x16_bf16 v[68:83], v[116:119], v[104:107], v[68:83]
    ds_read_b64_tr_b16 v[130:131], v4 offset:14848
    ds_read_b128 v[112:115], v23 offset:4096
    v_mfma_f32_32x32x16_bf16 v[84:99], v[120:123], v[104:107], v[84:99]
    s_cmp_lg_u32 s97, 0
    s_cbranch_scc1 k1_r19a
    ds_read_b64_tr_b16 v[136:137], v5 offset:6144
    ds_read_b64_tr_b16 v[138:139], v5 offset:6656
k1_r19a:
    s_waitcnt lgkmcnt(3)
    v_mfma_f32_32x32x16_bf16 v[36:51], v[124:127], v[108:111], v[36:51]
    s_cmp_lg_u32 s97, 0
    s_cbranch_scc1 k1_x19a
    v_lshlrev_b32 v28, 16, v132
    v_and_b32 v29, s63, v132
    v_add_f32 v156, v156, v28
    v_add_f32 v157, v157, v29
    v_lshlrev_b32 v28, 16, v133
    v_and_b32 v29, s63, v133
    v_add_f32 v156, v156, v28
    v_add_f32 v157, v157, v29
    v_lshlrev_b32 v28, 16, v134
    v_and_b32 v29, s63, v134
    v_add_f32 v156, v156, v28
    v_add_f32 v157, v157, v29
    v_lshlrev_b32 v28, 16, v135
    v_and_b32 v29, s63, v135
    v_add_f32 v156, v156, v28
    v_add_f32 v157, v157, v29
    s_branch k1_x19b
k1_x19a:
    v_mfma_f32_16x16x32_bf16 v[148:151], v[132:135], v[140:143], v[148:151]
k1_x19b:
    s_waitcnt lgkmcnt(1)
    v_mfma_f32_32x32x16_bf16 v[52:67], v[128:131], v[108:111], v[52:67]
    s_waitcnt lgkmcnt(0)
    s_barrier
    v_add_u32 v4, 53248, v4
    v_add_u32 v5, 53248, v5
    v_add_u32 v20, 53248, v20
    v_add_u32 v21, 53248, v21
    v_add_u32 v22, 53248, v22
    v_add_u32 v23, 53248, v23
    v_add_u32 v11, s3, v11
    v_xor_b32 v12, 64, v11
    ds_read_b128 v[100:103], v20 offset:0
    ds_read_b64_tr_b16 v[116:117], v4 offset:0
    ds_read_b64_tr_b16 v[118:119], v4 offset:512
    v_mfma_f32_32x32x16_bf16 v[68:83], v[124:127], v[112:115], v[68:83]
    ds_read_b64_tr_b16 v[120:121], v4 offset:8192
    ds_read_b64_tr_b16 v[122:123], v4 offset:8704
    ds_read_b128 v[104:107], v20 offset:4096
    v_mfma_f32_32x32x16_bf16 v[84:99], v[128:131], v[112:115], v[84:99]
    s_cmp_lg_u32 s97, 0
    s_cbranch_scc1 k1_r20a
    ds_read_b64_tr_b16 v[132:133], v5 offset:0
    ds_read_b64_tr_b16 v[134:135], v5 offset:512
    s_branch k1_r20b
k1_r20a:
    ds_read_b128 v[140:143], v11
    ds_read_b64_tr_b16 v[132:133], v5 offset:0
    ds_read_b64_tr_b16 v[134:135], v5 offset:160
k1_r20b:
    s_waitcnt lgkmcnt(3)
    v_mfma_f32_32x32x16_bf16 v[36:51], v[116:119], v[100:103], v[36:51]
    s_cmp_lg_u32 s97, 0
    s_cbranch_scc1 k1_x20a
    v_lshlrev_b32 v28, 16, v136
    v_and_b32 v29, s63, v136
    v_add_f32 v156, v156, v28
    v_add_f32 v157, v157, v29
    v_lshlrev_b32 v28, 16, v137
    v_and_b32 v29, s63, v137
    v_add_f32 v156, v156, v28
    v_add_f32 v157, v157, v29
    v_lshlrev_b32 v28, 16, v138
    v_and_b32 v29, s63, v138
    v_add_f32 v156, v156, v28
    v_add_f32 v157, v157, v29
    v_lshlrev_b32 v28, 16, v139
    v_and_b32 v29, s63, v139
    v_add_f32 v156, v156, v28
    v_add_f32 v157, v157, v29
    s_branch k1_x20b
k1_x20a:
k1_x20b:
    ds_read_b128 v[108:111], v21 offset:0
    ds_read_b64_tr_b16 v[124:125], v4 offset:2048
    s_waitcnt lgkmcnt(3)
    v_mfma_f32_32x32x16_bf16 v[52:67], v[120:123], v[100:103], v[52:67]
    ds_read_b64_tr_b16 v[126:127], v4 offset:2560
    ds_read_b64_tr_b16 v[128:129], v4 offset:10240
    s_waitcnt lgkmcnt(4)
    v_mfma_f32_32x32x16_bf16 v[68:83], v[116:119], v[104:107], v[68:83]
    ds_read_b64_tr_b16 v[130:131], v4 offset:10752
    ds_read_b128 v[112:115], v21 offset:4096
    v_mfma_f32_32x32x16_bf16 v[84:99], v[120:123], v[104:107], v[84:99]
    s_cmp_lg_u32 s97, 0
    s_cbranch_scc1 k1_r21a
    ds_read_b64_tr_b16 v[136:137], v5 offset:2048
    ds_read_b64_tr_b16 v[138:139], v5 offset:2560
k1_r21a:
    s_waitcnt lgkmcnt(3)
    v_mfma_f32_32x32x16_bf16 v[36:51], v[124:127], v[108:111], v[36:51]
    s_cmp_lg_u32 s97, 0
    s_cbranch_scc1 k1_x21a
    v_lshlrev_b32 v28, 16, v132
    v_and_b32 v29, s63, v132
    v_add_f32 v156, v156, v28
    v_add_f32 v157, v157, v29
    v_lshlrev_b32 v28, 16, v133
    v_and_b32 v29, s63, v133
    v_add_f32 v156, v156, v28
    v_add_f32 v157, v157, v29
    v_lshlrev_b32 v28, 16, v134
    v_and_b32 v29, s63, v134
    v_add_f32 v156, v156, v28
    v_add_f32 v157, v157, v29
    v_lshlrev_b32 v28, 16, v135
    v_and_b32 v29, s63, v135
    v_add_f32 v156, v156, v28
    v_add_f32 v157, v157, v29
    s_branch k1_x21b
k1_x21a:
    v_mfma_f32_16x16x32_bf16 v[148:151], v[132:135], v[140:143], v[148:151]
k1_x21b:
    ds_read_b128 v[100:103], v22 offset:0
    ds_read_b64_tr_b16 v[116:117], v4 offset:4096
    s_waitcnt lgkmcnt(3)
    v_mfma_f32_32x32x16_bf16 v[52:67], v[128:131], v[108:111], v[52:67]
    ds_read_b64_tr_b16 v[118:119], v4 offset:4608
    ds_read_b64_tr_b16 v[120:121], v4 offset:12288
    s_waitcnt lgkmcnt(4)
    v_mfma_f32_32x32x16_bf16 v[68:83], v[124:127], v[112:115], v[68:83]
    ds_read_b64_tr_b16 v[122:123], v4 offset:12800
    ds_read_b128 v[104:107], v22 offset:4096
    v_mfma_f32_32x32x16_bf16 v[84:99], v[128:131], v[112:115], v[84:99]
    s_cmp_lg_u32 s97, 0
    s_cbranch_scc1 k1_r22a
    ds_read_b64_tr_b16 v[132:133], v5 offset:4096
    ds_read_b64_tr_b16 v[134:135], v5 offset:4608
    s_branch k1_r22b
k1_r22a:
    ds_read_b128 v[140:143], v12
    ds_read_b64_tr_b16 v[132:133], v5 offset:1280
    ds_read_b64_tr_b16 v[134:135], v5 offset:1440
k1_r22b:
    s_waitcnt lgkmcnt(3)
    v_mfma_f32_32x32x16_bf16 v[36:51], v[116:119], v[100:103], v[36:51]
    s_cmp_lg_u32 s97, 0
    s_cbranch_scc1 k1_x22a
    v_lshlrev_b32 v28, 16, v136
    v_and_b32 v29, s63, v136
    v_add_f32 v156, v156, v28
    v_add_f32 v157, v157, v29
    v_lshlrev_b32 v28, 16, v137
    v_and_b32 v29, s63, v137
    v_add_f32 v156, v156, v28
    v_add_f32 v157, v157, v29
    v_lshlrev_b32 v28, 16, v138
    v_and_b32 v29, s63, v138
    v_add_f32 v156, v156, v28
    v_add_f32 v157, v157, v29
    v_lshlrev_b32 v28, 16, v139
    v_and_b32 v29, s63, v139
    v_add_f32 v156, v156, v28
    v_add_f32 v157, v157, v29
    s_branch k1_x22b
k1_x22a:
k1_x22b:
    ds_read_b128 v[108:111], v23 offset:0
    ds_read_b64_tr_b16 v[124:125], v4 offset:6144
    s_waitcnt lgkmcnt(3)
    v_mfma_f32_32x32x16_bf16 v[52:67], v[120:123], v[100:103], v[52:67]
    ds_read_b64_tr_b16 v[126:127], v4 offset:6656
    ds_read_b64_tr_b16 v[128:129], v4 offset:14336
    s_waitcnt lgkmcnt(4)
    v_mfma_f32_32x32x16_bf16 v[68:83], v[116:119], v[104:107], v[68:83]
    ds_read_b64_tr_b16 v[130:131], v4 offset:14848
    ds_read_b128 v[112:115], v23 offset:4096
    v_mfma_f32_32x32x16_bf16 v[84:99], v[120:123], v[104:107], v[84:99]
    s_cmp_lg_u32 s97, 0
    s_cbranch_scc1 k1_r23a
    ds_read_b64_tr_b16 v[136:137], v5 offset:6144
    ds_read_b64_tr_b16 v[138:139], v5 offset:6656
k1_r23a:
    s_waitcnt lgkmcnt(3)
    v_mfma_f32_32x32x16_bf16 v[36:51], v[124:127], v[108:111], v[36:51]
    s_cmp_lg_u32 s97, 0
    s_cbranch_scc1 k1_x23a
    v_lshlrev_b32 v28, 16, v132
    v_and_b32 v29, s63, v132
    v_add_f32 v156, v156, v28
    v_add_f32 v157, v157, v29
    v_lshlrev_b32 v28, 16, v133
    v_and_b32 v29, s63, v133
    v_add_f32 v156, v156, v28
    v_add_f32 v157, v157, v29
    v_lshlrev_b32 v28, 16, v134
    v_and_b32 v29, s63, v134
    v_add_f32 v156, v156, v28
    v_add_f32 v157, v157, v29
    v_lshlrev_b32 v28, 16, v135
    v_and_b32 v29, s63, v135
    v_add_f32 v156, v156, v28
    v_add_f32 v157, v157, v29
    s_branch k1_x23b
k1_x23a:
    v_mfma_f32_16x16x32_bf16 v[148:151], v[132:135], v[140:143], v[148:151]
k1_x23b:
    s_waitcnt lgkmcnt(1)
    v_mfma_f32_32x32x16_bf16 v[52:67], v[128:131], v[108:111], v[52:67]
    s_waitcnt lgkmcnt(0)
    s_barrier
    v_add_u32 v4, 4294860800, v4
    v_add_u32 v5, 4294860800, v5
    v_add_u32 v20, 4294860800, v20
    v_add_u32 v21, 4294860800, v21
    v_add_u32 v22, 4294860800, v22
    v_add_u32 v23, 4294860800, v23
    v_add_u32 v11, s4, v11
    v_xor_b32 v12, 64, v11
    ds_read_b128 v[100:103], v20 offset:0
    ds_read_b64_tr_b16 v[116:117], v4 offset:0
    ds_read_b64_tr_b16 v[118:119], v4 offset:512
    v_mfma_f32_32x32x16_bf16 v[68:83], v[124:127], v[112:115], v[68:83]
    ds_read_b64_tr_b16 v[120:121], v4 offset:8192
    ds_read_b64_tr_b16 v[122:123], v4 offset:8704
    ds_read_b128 v[104:107], v20 offset:4096
    v_mfma_f32_32x32x16_bf16 v[84:99], v[128:131], v[112:115], v[84:99]
    s_cmp_lg_u32 s97, 0
    s_cbranch_scc1 k1_r24a
    ds_read_b64_tr_b16 v[132:133], v5 offset:0
    ds_read_b64_tr_b16 v[134:135], v5 offset:512
    s_branch k1_r24b
k1_r24a:
    ds_read_b128 v[140:143], v11
    ds_read_b64_tr_b16 v[132:133], v5 offset:0
    ds_read_b64_tr_b16 v[134:135], v5 offset:160
k1_r24b:
    s_waitcnt lgkmcnt(3)
    v_mfma_f32_32x32x16_bf16 v[36:51], v[116:119], v[100:103], v[36:51]
    s_cmp_lg_u32 s97, 0
    s_cbranch_scc1 k1_x24a
    v_lshlrev_b32 v28, 16, v136
    v_and_b32 v29, s63, v136
    v_add_f32 v156, v156, v28
    v_add_f32 v157, v157, v29
    v_lshlrev_b32 v28, 16, v137
    v_and_b32 v29, s63, v137
    v_add_f32 v156, v156, v28
    v_add_f32 v157, v157, v29
    v_lshlrev_b32 v28, 16, v138
    v_and_b32 v29, s63, v138
    v_add_f32 v156, v156, v28
    v_add_f32 v157, v157, v29
    v_lshlrev_b32 v28, 16, v139
    v_and_b32 v29, s63, v139
    v_add_f32 v156, v156, v28
    v_add_f32 v157, v157, v29
    s_branch k1_x24b
k1_x24a:
k1_x24b:
    ds_read_b128 v[108:111], v21 offset:0
    ds_read_b64_tr_b16 v[124:125], v4 offset:2048
    s_waitcnt lgkmcnt(3)
    v_mfma_f32_32x32x16_bf16 v[52:67], v[120:123], v[100:103], v[52:67]
    ds_read_b64_tr_b16 v[126:127], v4 offset:2560
    ds_read_b64_tr_b16 v[128:129], v4 offset:10240
    s_waitcnt lgkmcnt(4)
    v_mfma_f32_32x32x16_bf16 v[68:83], v[116:119], v[104:107], v[68:83]
    ds_read_b64_tr_b16 v[130:131], v4 offset:10752
    ds_read_b128 v[112:115], v21 offset:4096
    v_mfma_f32_32x32x16_bf16 v[84:99], v[120:123], v[104:107], v[84:99]
    s_cmp_lg_u32 s97, 0
    s_cbranch_scc1 k1_r25a
    ds_read_b64_tr_b16 v[136:137], v5 offset:2048
    ds_read_b64_tr_b16 v[138:139], v5 offset:2560
k1_r25a:
    s_waitcnt lgkmcnt(3)
    v_mfma_f32_32x32x16_bf16 v[36:51], v[124:127], v[108:111], v[36:51]
    s_cmp_lg_u32 s97, 0
    s_cbranch_scc1 k1_x25a
    v_lshlrev_b32 v28, 16, v132
    v_and_b32 v29, s63, v132
    v_add_f32 v156, v156, v28
    v_add_f32 v157, v157, v29
    v_lshlrev_b32 v28, 16, v133
    v_and_b32 v29, s63, v133
    v_add_f32 v156, v156, v28
    v_add_f32 v157, v157, v29
    v_lshlrev_b32 v28, 16, v134
    v_and_b32 v29, s63, v134
    v_add_f32 v156, v156, v28
    v_add_f32 v157, v157, v29
    v_lshlrev_b32 v28, 16, v135
    v_and_b32 v29, s63, v135
    v_add_f32 v156, v156, v28
    v_add_f32 v157, v157, v29
    s_branch k1_x25b
k1_x25a:
    v_mfma_f32_16x16x32_bf16 v[148:151], v[132:135], v[140:143], v[148:151]
k1_x25b:
    ds_read_b128 v[100:103], v22 offset:0
    ds_read_b64_tr_b16 v[116:117], v4 offset:4096
    s_waitcnt lgkmcnt(3)
    v_mfma_f32_32x32x16_bf16 v[52:67], v[128:131], v[108:111], v[52:67]
    ds_read_b64_tr_b16 v[118:119], v4 offset:4608
    ds_read_b64_tr_b16 v[120:121], v4 offset:12288
    s_waitcnt lgkmcnt(4)
    v_mfma_f32_32x32x16_bf16 v[68:83], v[124:127], v[112:115], v[68:83]
    ds_read_b64_tr_b16 v[122:123], v4 offset:12800
    ds_read_b128 v[104:107], v22 offset:4096
    v_mfma_f32_32x32x16_bf16 v[84:99], v[128:131], v[112:115], v[84:99]
    s_cmp_lg_u32 s97, 0
    s_cbranch_scc1 k1_r26a
    ds_read_b64_tr_b16 v[132:133], v5 offset:4096
    ds_read_b64_tr_b16 v[134:135], v5 offset:4608
    s_branch k1_r26b
k1_r26a:
    ds_read_b128 v[140:143], v12
    ds_read_b64_tr_b16 v[132:133], v5 offset:1280
    ds_read_b64_tr_b16 v[134:135], v5 offset:1440
k1_r26b:
    s_waitcnt lgkmcnt(3)
    v_mfma_f32_32x32x16_bf16 v[36:51], v[116:119], v[100:103], v[36:51]
    s_cmp_lg_u32 s97, 0
    s_cbranch_scc1 k1_x26a
    v_lshlrev_b32 v28, 16, v136
    v_and_b32 v29, s63, v136
    v_add_f32 v156, v156, v28
    v_add_f32 v157, v157, v29
    v_lshlrev_b32 v28, 16, v137
    v_and_b32 v29, s63, v137
    v_add_f32 v156, v156, v28
    v_add_f32 v157, v157, v29
    v_lshlrev_b32 v28, 16, v138
    v_and_b32 v29, s63, v138
    v_add_f32 v156, v156, v28
    v_add_f32 v157, v157, v29
    v_lshlrev_b32 v28, 16, v139
    v_and_b32 v29, s63, v139
    v_add_f32 v156, v156, v28
    v_add_f32 v157, v157, v29
    s_branch k1_x26b
k1_x26a:
k1_x26b:
    ds_read_b128 v[108:111], v23 offset:0
    ds_read_b64_tr_b16 v[124:125], v4 offset:6144
    s_waitcnt lgkmcnt(3)
    v_mfma_f32_32x32x16_bf16 v[52:67], v[120:123], v[100:103], v[52:67]
    ds_read_b64_tr_b16 v[126:127], v4 offset:6656
    ds_read_b64_tr_b16 v[128:129], v4 offset:14336
    s_waitcnt lgkmcnt(4)
    v_mfma_f32_32x32x16_bf16 v[68:83], v[116:119], v[104:107], v[68:83]
    ds_read_b64_tr_b16 v[130:131], v4 offset:14848
    ds_read_b128 v[112:115], v23 offset:4096
    v_mfma_f32_32x32x16_bf16 v[84:99], v[120:123], v[104:107], v[84:99]
    s_cmp_lg_u32 s97, 0
    s_cbranch_scc1 k1_r27a
    ds_read_b64_tr_b16 v[136:137], v5 offset:6144
    ds_read_b64_tr_b16 v[138:139], v5 offset:6656
k1_r27a:
    s_waitcnt lgkmcnt(3)
    v_mfma_f32_32x32x16_bf16 v[36:51], v[124:127], v[108:111], v[36:51]
    s_cmp_lg_u32 s97, 0
    s_cbranch_scc1 k1_x27a
    v_lshlrev_b32 v28, 16, v132
    v_and_b32 v29, s63, v132
    v_add_f32 v156, v156, v28
    v_add_f32 v157, v157, v29
    v_lshlrev_b32 v28, 16, v133
    v_and_b32 v29, s63, v133
    v_add_f32 v156, v156, v28
    v_add_f32 v157, v157, v29
    v_lshlrev_b32 v28, 16, v134
    v_and_b32 v29, s63, v134
    v_add_f32 v156, v156, v28
    v_add_f32 v157, v157, v29
    v_lshlrev_b32 v28, 16, v135
    v_and_b32 v29, s63, v135
    v_add_f32 v156, v156, v28
    v_add_f32 v157, v157, v29
    s_branch k1_x27b
k1_x27a:
    v_mfma_f32_16x16x32_bf16 v[148:151], v[132:135], v[140:143], v[148:151]
k1_x27b:
    s_waitcnt lgkmcnt(1)
    v_mfma_f32_32x32x16_bf16 v[52:67], v[128:131], v[108:111], v[52:67]
    s_waitcnt lgkmcnt(0)
    s_barrier
    v_add_u32 v4, 53248, v4
    v_add_u32 v5, 53248, v5
    v_add_u32 v20, 53248, v20
    v_add_u32 v21, 53248, v21
    v_add_u32 v22, 53248, v22
    v_add_u32 v23, 53248, v23
    v_add_u32 v11, s3, v11
    v_xor_b32 v12, 64, v11
    ds_read_b128 v[100:103], v20 offset:0
    ds_read_b64_tr_b16 v[116:117], v4 offset:0
    ds_read_b64_tr_b16 v[118:119], v4 offset:512
    v_mfma_f32_32x32x16_bf16 v[68:83], v[124:127], v[112:115], v[68:83]
    ds_read_b64_tr_b16 v[120:121], v4 offset:8192
    ds_read_b64_tr_b16 v[122:123], v4 offset:8704
    ds_read_b128 v[104:107], v20 offset:4096
    v_mfma_f32_32x32x16_bf16 v[84:99], v[128:131], v[112:115], v[84:99]
    s_cmp_lg_u32 s97, 0
    s_cbranch_scc1 k1_r28a
    ds_read_b64_tr_b16 v[132:133], v5 offset:0
    ds_read_b64_tr_b16 v[134:135], v5 offset:512
    s_branch k1_r28b
k1_r28a:
    ds_read_b128 v[140:143], v11
    ds_read_b64_tr_b16 v[132:133], v5 offset:0
    ds_read_b64_tr_b16 v[134:135], v5 offset:160
k1_r28b:
    s_waitcnt lgkmcnt(3)
    v_mfma_f32_32x32x16_bf16 v[36:51], v[116:119], v[100:103], v[36:51]
    s_cmp_lg_u32 s97, 0
    s_cbranch_scc1 k1_x28a
    v_lshlrev_b32 v28, 16, v136
    v_and_b32 v29, s63, v136
    v_add_f32 v156, v156, v28
    v_add_f32 v157, v157, v29
    v_lshlrev_b32 v28, 16, v137
    v_and_b32 v29, s63, v137
    v_add_f32 v156, v156, v28
    v_add_f32 v157, v157, v29
    v_lshlrev_b32 v28, 16, v138
    v_and_b32 v29, s63, v138
    v_add_f32 v156, v156, v28
    v_add_f32 v157, v157, v29
    v_lshlrev_b32 v28, 16, v139
    v_and_b32 v29, s63, v139
    v_add_f32 v156, v156, v28
    v_add_f32 v157, v157, v29
    s_branch k1_x28b
k1_x28a:
k1_x28b:
    ds_read_b128 v[108:111], v21 offset:0
    ds_read_b64_tr_b16 v[124:125], v4 offset:2048
    s_waitcnt lgkmcnt(3)
    v_mfma_f32_32x32x16_bf16 v[52:67], v[120:123], v[100:103], v[52:67]
    ds_read_b64_tr_b16 v[126:127], v4 offset:2560
    ds_read_b64_tr_b16 v[128:129], v4 offset:10240
    s_waitcnt lgkmcnt(4)
    v_mfma_f32_32x32x16_bf16 v[68:83], v[116:119], v[104:107], v[68:83]
    ds_read_b64_tr_b16 v[130:131], v4 offset:10752
    ds_read_b128 v[112:115], v21 offset:4096
    v_mfma_f32_32x32x16_bf16 v[84:99], v[120:123], v[104:107], v[84:99]
    s_cmp_lg_u32 s97, 0
    s_cbranch_scc1 k1_r29a
    ds_read_b64_tr_b16 v[136:137], v5 offset:2048
    ds_read_b64_tr_b16 v[138:139], v5 offset:2560
k1_r29a:
    s_waitcnt lgkmcnt(3)
    v_mfma_f32_32x32x16_bf16 v[36:51], v[124:127], v[108:111], v[36:51]
    s_cmp_lg_u32 s97, 0
    s_cbranch_scc1 k1_x29a
    v_lshlrev_b32 v28, 16, v132
    v_and_b32 v29, s63, v132
    v_add_f32 v156, v156, v28
    v_add_f32 v157, v157, v29
    v_lshlrev_b32 v28, 16, v133
    v_and_b32 v29, s63, v133
    v_add_f32 v156, v156, v28
    v_add_f32 v157, v157, v29
    v_lshlrev_b32 v28, 16, v134
    v_and_b32 v29, s63, v134
    v_add_f32 v156, v156, v28
    v_add_f32 v157, v157, v29
    v_lshlrev_b32 v28, 16, v135
    v_and_b32 v29, s63, v135
    v_add_f32 v156, v156, v28
    v_add_f32 v157, v157, v29
    s_branch k1_x29b
k1_x29a:
    v_mfma_f32_16x16x32_bf16 v[148:151], v[132:135], v[140:143], v[148:151]
k1_x29b:
    ds_read_b128 v[100:103], v22 offset:0
    ds_read_b64_tr_b16 v[116:117], v4 offset:4096
    s_waitcnt lgkmcnt(3)
    v_mfma_f32_32x32x16_bf16 v[52:67], v[128:131], v[108:111], v[52:67]
    ds_read_b64_tr_b16 v[118:119], v4 offset:4608
    ds_read_b64_tr_b16 v[120:121], v4 offset:12288
    s_waitcnt lgkmcnt(4)
    v_mfma_f32_32x32x16_bf16 v[68:83], v[124:127], v[112:115], v[68:83]
    ds_read_b64_tr_b16 v[122:123], v4 offset:12800
    ds_read_b128 v[104:107], v22 offset:4096
    v_mfma_f32_32x32x16_bf16 v[84:99], v[128:131], v[112:115], v[84:99]
    s_cmp_lg_u32 s97, 0
    s_cbranch_scc1 k1_r30a
    ds_read_b64_tr_b16 v[132:133], v5 offset:4096
    ds_read_b64_tr_b16 v[134:135], v5 offset:4608
    s_branch k1_r30b
k1_r30a:
    ds_read_b128 v[140:143], v12
    ds_read_b64_tr_b16 v[132:133], v5 offset:1280
    ds_read_b64_tr_b16 v[134:135], v5 offset:1440
k1_r30b:
    s_waitcnt lgkmcnt(3)
    v_mfma_f32_32x32x16_bf16 v[36:51], v[116:119], v[100:103], v[36:51]
    s_cmp_lg_u32 s97, 0
    s_cbranch_scc1 k1_x30a
    v_lshlrev_b32 v28, 16, v136
    v_and_b32 v29, s63, v136
    v_add_f32 v156, v156, v28
    v_add_f32 v157, v157, v29
    v_lshlrev_b32 v28, 16, v137
    v_and_b32 v29, s63, v137
    v_add_f32 v156, v156, v28
    v_add_f32 v157, v157, v29
    v_lshlrev_b32 v28, 16, v138
    v_and_b32 v29, s63, v138
    v_add_f32 v156, v156, v28
    v_add_f32 v157, v157, v29
    v_lshlrev_b32 v28, 16, v139
    v_and_b32 v29, s63, v139
    v_add_f32 v156, v156, v28
    v_add_f32 v157, v157, v29
    s_branch k1_x30b
k1_x30a:
k1_x30b:
    ds_read_b128 v[108:111], v23 offset:0
    ds_read_b64_tr_b16 v[124:125], v4 offset:6144
    s_waitcnt lgkmcnt(3)
    v_mfma_f32_32x32x16_bf16 v[52:67], v[120:123], v[100:103], v[52:67]
    ds_read_b64_tr_b16 v[126:127], v4 offset:6656
    ds_read_b64_tr_b16 v[128:129], v4 offset:14336
    s_waitcnt lgkmcnt(4)
    v_mfma_f32_32x32x16_bf16 v[68:83], v[116:119], v[104:107], v[68:83]
    ds_read_b64_tr_b16 v[130:131], v4 offset:14848
    ds_read_b128 v[112:115], v23 offset:4096
    v_mfma_f32_32x32x16_bf16 v[84:99], v[120:123], v[104:107], v[84:99]
    s_cmp_lg_u32 s97, 0
    s_cbranch_scc1 k1_r31a
    ds_read_b64_tr_b16 v[136:137], v5 offset:6144
    ds_read_b64_tr_b16 v[138:139], v5 offset:6656
k1_r31a:
    s_waitcnt lgkmcnt(3)
    v_mfma_f32_32x32x16_bf16 v[36:51], v[124:127], v[108:111], v[36:51]
    s_cmp_lg_u32 s97, 0
    s_cbranch_scc1 k1_x31a
    v_lshlrev_b32 v28, 16, v132
    v_and_b32 v29, s63, v132
    v_add_f32 v156, v156, v28
    v_add_f32 v157, v157, v29
    v_lshlrev_b32 v28, 16, v133
    v_and_b32 v29, s63, v133
    v_add_f32 v156, v156, v28
    v_add_f32 v157, v157, v29
    v_lshlrev_b32 v28, 16, v134
    v_and_b32 v29, s63, v134
    v_add_f32 v156, v156, v28
    v_add_f32 v157, v157, v29
    v_lshlrev_b32 v28, 16, v135
    v_and_b32 v29, s63, v135
    v_add_f32 v156, v156, v28
    v_add_f32 v157, v157, v29
    s_branch k1_x31b
k1_x31a:
    v_mfma_f32_16x16x32_bf16 v[148:151], v[132:135], v[140:143], v[148:151]
k1_x31b:
    s_waitcnt lgkmcnt(1)
    v_mfma_f32_32x32x16_bf16 v[52:67], v[128:131], v[108:111], v[52:67]
    s_waitcnt lgkmcnt(0)
    s_barrier
    v_add_u32 v4, 53248, v4
    v_add_u32 v5, 53248, v5
    v_add_u32 v20, 53248, v20
    v_add_u32 v21, 53248, v21
    v_add_u32 v22, 53248, v22
    v_add_u32 v23, 53248, v23
    v_add_u32 v11, s3, v11
    v_xor_b32 v12, 64, v11
    ds_read_b128 v[100:103], v20 offset:0
    ds_read_b64_tr_b16 v[116:117], v4 offset:0
    ds_read_b64_tr_b16 v[118:119], v4 offset:512
    v_mfma_f32_32x32x16_bf16 v[68:83], v[124:127], v[112:115], v[68:83]
    ds_read_b64_tr_b16 v[120:121], v4 offset:8192
    ds_read_b64_tr_b16 v[122:123], v4 offset:8704
    ds_read_b128 v[104:107], v20 offset:4096
    v_mfma_f32_32x32x16_bf16 v[84:99], v[128:131], v[112:115], v[84:99]
    s_lshl_b32 s17, s15, 5
    v_mov_b32 v26, s17
    s_cmp_lg_u32 s14, 0
    s_cbranch_scc1 k1_nopl
    global_load_dword v27, v26, s[56:57] sc1
k1_nopl:
    s_cmp_lg_u32 s97, 0
    s_cbranch_scc1 k1_r32a
    ds_read_b64_tr_b16 v[132:133], v5 offset:0
    ds_read_b64_tr_b16 v[134:135], v5 offset:512
    s_branch k1_r32b
k1_r32a:
    ds_read_b128 v[140:143], v11
    ds_read_b64_tr_b16 v[132:133], v5 offset:0
    ds_read_b64_tr_b16 v[134:135], v5 offset:160
k1_r32b:
    s_waitcnt lgkmcnt(3)
    v_mfma_f32_32x32x16_bf16 v[36:51], v[116:119], v[100:103], v[36:51]
    s_cmp_lg_u32 s97, 0
    s_cbranch_scc1 k1_x32a
    v_lshlrev_b32 v28, 16, v136
    v_and_b32 v29, s63, v136
    v_add_f32 v156, v156, v28
    v_add_f32 v157, v157, v29
    v_lshlrev_b32 v28, 16, v137
    v_and_b32 v29, s63, v137
    v_add_f32 v156, v156, v28
    v_add_f32 v157, v157, v29
    v_lshlrev_b32 v28, 16, v138
    v_and_b32 v29, s63, v138
    v_add_f32 v156, v156, v28
    v_add_f32 v157, v157, v29
    v_lshlrev_b32 v28, 16, v139
    v_and_b32 v29, s63, v139
    v_add_f32 v156, v156, v28
    v_add_f32 v157, v157, v29
    s_branch k1_x32b
k1_x32a:
k1_x32b:
    ds_read_b128 v[108:111], v21 offset:0
    ds_read_b64_tr_b16 v[124:125], v4 offset:2048
    s_waitcnt lgkmcnt(3)
    v_mfma_f32_32x32x16_bf16 v[52:67], v[120:123], v[100:103], v[52:67]
    ds_read_b64_tr_b16 v[126:127], v4 offset:2560
    ds_read_b64_tr_b16 v[128:129], v4 offset:10240
    s_waitcnt lgkmcnt(4)
    v_mfma_f32_32x32x16_bf16 v[68:83], v[116:119], v[104:107], v[68:83]
    ds_read_b64_tr_b16 v[130:131], v4 offset:10752
    ds_read_b128 v[112:115], v21 offset:4096
    v_mfma_f32_32x32x16_bf16 v[84:99], v[120:123], v[104:107], v[84:99]
    s_cmp_lg_u32 s97, 0
    s_cbranch_scc1 k1_r33a
    ds_read_b64_tr_b16 v[136:137], v5 offset:2048
    ds_read_b64_tr_b16 v[138:139], v5 offset:2560
k1_r33a:
    s_waitcnt lgkmcnt(3)
    v_mfma_f32_32x32x16_bf16 v[36:51], v[124:127], v[108:111], v[36:51]
    s_cmp_lg_u32 s97, 0
    s_cbranch_scc1 k1_x33a
    v_lshlrev_b32 v28, 16, v132
    v_and_b32 v29, s63, v132
    v_add_f32 v156, v156, v28
    v_add_f32 v157, v157, v29
    v_lshlrev_b32 v28, 16, v133
    v_and_b32 v29, s63, v133
    v_add_f32 v156, v156, v28
    v_add_f32 v157, v157, v29
    v_lshlrev_b32 v28, 16, v134
    v_and_b32 v29, s63, v134
    v_add_f32 v156, v156, v28
    v_add_f32 v157, v157, v29
    v_lshlrev_b32 v28, 16, v135
    v_and_b32 v29, s63, v135
    v_add_f32 v156, v156, v28
    v_add_f32 v157, v157, v29
    s_branch k1_x33b
k1_x33a:
    v_mfma_f32_16x16x32_bf16 v[148:151], v[132:135], v[140:143], v[148:151]
k1_x33b:
    ds_read_b128 v[100:103], v22 offset:0
    ds_read_b64_tr_b16 v[116:117], v4 offset:4096
    s_waitcnt lgkmcnt(3)
    v_mfma_f32_32x32x16_bf16 v[52:67], v[128:131], v[108:111], v[52:67]
    ds_read_b64_tr_b16 v[118:119], v4 offset:4608
    ds_read_b64_tr_b16 v[120:121], v4 offset:12288
    s_waitcnt lgkmcnt(4)
    v_mfma_f32_32x32x16_bf16 v[68:83], v[124:127], v[112:115], v[68:83]
    ds_read_b64_tr_b16 v[122:123], v4 offset:12800
    ds_read_b128 v[104:107], v22 offset:4096
    v_mfma_f32_32x32x16_bf16 v[84:99], v[128:131], v[112:115], v[84:99]
    s_cmp_lg_u32 s97, 0
    s_cbranch_scc1 k1_r34a
    ds_read_b64_tr_b16 v[132:133], v5 offset:4096
    ds_read_b64_tr_b16 v[134:135], v5 offset:4608
    s_branch k1_r34b
k1_r34a:
    ds_read_b128 v[140:143], v12
    ds_read_b64_tr_b16 v[132:133], v5 offset:1280
    ds_read_b64_tr_b16 v[134:135], v5 offset:1440
k1_r34b:
    s_waitcnt lgkmcnt(3)
    v_mfma_f32_32x32x16_bf16 v[36:51], v[116:119], v[100:103], v[36:51]
    s_cmp_lg_u32 s97, 0
    s_cbranch_scc1 k1_x34a
    v_lshlrev_b32 v28, 16, v136
    v_and_b32 v29, s63, v136
    v_add_f32 v156, v156, v28
    v_add_f32 v157, v157, v29
    v_lshlrev_b32 v28, 16, v137
    v_and_b32 v29, s63, v137
    v_add_f32 v156, v156, v28
    v_add_f32 v157, v157, v29
    v_lshlrev_b32 v28, 16, v138
    v_and_b32 v29, s63, v138
    v_add_f32 v156, v156, v28
    v_add_f32 v157, v157, v29
    v_lshlrev_b32 v28, 16, v139
    v_and_b32 v29, s63, v139
    v_add_f32 v156, v156, v28
    v_add_f32 v157, v157, v29
    s_branch k1_x34b
k1_x34a:
k1_x34b:
    ds_read_b128 v[108:111], v23 offset:0
    ds_read_b64_tr_b16 v[124:125], v4 offset:6144
    s_waitcnt lgkmcnt(3)
    v_mfma_f32_32x32x16_bf16 v[52:67], v[120:123], v[100:103], v[52:67]
    ds_read_b64_tr_b16 v[126:127], v4 offset:6656
    ds_read_b64_tr_b16 v[128:129], v4 offset:14336
    s_waitcnt lgkmcnt(4)
    v_mfma_f32_32x32x16_bf16 v[68:83], v[116:119], v[104:107], v[68:83]
    ds_read_b64_tr_b16 v[130:131], v4 offset:14848
    ds_read_b128 v[112:115], v23 offset:4096
    v_mfma_f32_32x32x16_bf16 v[84:99], v[120:123], v[104:107], v[84:99]
    s_cmp_lg_u32 s14, 0
    s_cbranch_scc1 k1_pgo
    s_mov_b32 s17, 40000
    s_mov_b32 s19, 32
k1_poll:
    s_waitcnt vmcnt(0)
    v_cmp_ne_u32 vcc, s19, v27
    s_nop 0
    s_cmp_eq_u64 vcc, 0
    s_cbranch_scc1 k1_pgo
    s_sleep 8
    global_load_dword v27, v26, s[56:57] sc1
    s_sub_u32 s17, s17, 1
    s_cmp_lg_u32 s17, 0
    s_cbranch_scc1 k1_poll
k1_pgo:
    s_cmp_lg_u32 s97, 0
    s_cbranch_scc1 k1_r35a
    ds_read_b64_tr_b16 v[136:137], v5 offset:6144
    ds_read_b64_tr_b16 v[138:139], v5 offset:6656
k1_r35a:
    s_waitcnt lgkmcnt(3)
    v_mfma_f32_32x32x16_bf16 v[36:51], v[124:127], v[108:111], v[36:51]
    s_cmp_lg_u32 s97, 0
    s_cbranch_scc1 k1_x35a
    v_lshlrev_b32 v28, 16, v132
    v_and_b32 v29, s63, v132
    v_add_f32 v156, v156, v28
    v_add_f32 v157, v157, v29
    v_lshlrev_b32 v28, 16, v133
    v_and_b32 v29, s63, v133
    v_add_f32 v156, v156, v28
    v_add_f32 v157, v157, v29
    v_lshlrev_b32 v28, 16, v134
    v_and_b32 v29, s63, v134
    v_add_f32 v156, v156, v28
    v_add_f32 v157, v157, v29
    v_lshlrev_b32 v28, 16, v135
    v_and_b32 v29, s63, v135
    v_add_f32 v156, v156, v28
    v_add_f32 v157, v157, v29
    s_branch k1_x35b
k1_x35a:
    v_mfma_f32_16x16x32_bf16 v[148:151], v[132:135], v[140:143], v[148:151]
k1_x35b:
    s_waitcnt lgkmcnt(1)
    v_mfma_f32_32x32x16_bf16 v[52:67], v[128:131], v[108:111], v[52:67]
    s_waitcnt lgkmcnt(0)
    s_barrier
    v_and_b32 v6, 31, v1
    v_lshlrev_b32 v6, 3, v6
    s_lshl_b32 s17, s15, 2
    s_add_u32 s17, s17, s96
    s_lshl_b32 s17, s17, 9
    s_add_u32 s17, s17, 7405568
    buffer_load_dwordx2 v[158:159], v6, s[44:47], s17 offen sc1
    buffer_load_dwordx2 v[160:161], v6, s[44:47], s17 offen offset:256 sc1
    v_lshlrev_b32 v6, 3, v13
    s_lshl_b32 s17, s15, 4
    s_add_u32 s17, s17, s62
    s_lshl_b32 s17, s17, 7
    s_add_u32 s17, s17, 7405568
    buffer_load_dwordx2 v[162:163], v6, s[44:47], s17 offen sc1
    v_add_u32 v4, 4294860800, v4
    v_add_u32 v5, 4294860800, v5
    v_add_u32 v20, 4294860800, v20
    v_add_u32 v21, 4294860800, v21
    v_add_u32 v22, 4294860800, v22
    v_add_u32 v23, 4294860800, v23
    v_add_u32 v11, s4, v11
    v_xor_b32 v12, 64, v11
    ds_read_b128 v[100:103], v20 offset:0
    ds_read_b64_tr_b16 v[116:117], v4 offset:0
    ds_read_b64_tr_b16 v[118:119], v4 offset:512
    v_mfma_f32_32x32x16_bf16 v[68:83], v[124:127], v[112:115], v[68:83]
    ds_read_b64_tr_b16 v[120:121], v4 offset:8192
    ds_read_b64_tr_b16 v[122:123], v4 offset:8704
    ds_read_b128 v[104:107], v20 offset:4096
    v_mfma_f32_32x32x16_bf16 v[84:99], v[128:131], v[112:115], v[84:99]
    s_cmp_lg_u32 s97, 0
    s_cbranch_scc1 k1_r36a
    ds_read_b64_tr_b16 v[132:133], v5 offset:0
    ds_read_b64_tr_b16 v[134:135], v5 offset:512
    s_branch k1_r36b
k1_r36a:
    ds_read_b128 v[140:143], v11
    ds_read_b64_tr_b16 v[132:133], v5 offset:0
    ds_read_b64_tr_b16 v[134:135], v5 offset:160
k1_r36b:
    s_waitcnt lgkmcnt(3)
    v_mfma_f32_32x32x16_bf16 v[36:51], v[116:119], v[100:103], v[36:51]
    s_cmp_lg_u32 s97, 0
    s_cbranch_scc1 k1_x36a
    v_lshlrev_b32 v28, 16, v136
    v_and_b32 v29, s63, v136
    v_add_f32 v156, v156, v28
    v_add_f32 v157, v157, v29
    v_lshlrev_b32 v28, 16, v137
    v_and_b32 v29, s63, v137
    v_add_f32 v156, v156, v28
    v_add_f32 v157, v157, v29
    v_lshlrev_b32 v28, 16, v138
    v_and_b32 v29, s63, v138
    v_add_f32 v156, v156, v28
    v_add_f32 v157, v157, v29
    v_lshlrev_b32 v28, 16, v139
    v_and_b32 v29, s63, v139
    v_add_f32 v156, v156, v28
    v_add_f32 v157, v157, v29
    s_branch k1_x36b
k1_x36a:
k1_x36b:
    ds_read_b128 v[108:111], v21 offset:0
    ds_read_b64_tr_b16 v[124:125], v4 offset:2048
    s_waitcnt lgkmcnt(3)
    v_mfma_f32_32x32x16_bf16 v[52:67], v[120:123], v[100:103], v[52:67]
    ds_read_b64_tr_b16 v[126:127], v4 offset:2560
    ds_read_b64_tr_b16 v[128:129], v4 offset:10240
    s_waitcnt lgkmcnt(4)
    v_mfma_f32_32x32x16_bf16 v[68:83], v[116:119], v[104:107], v[68:83]
    ds_read_b64_tr_b16 v[130:131], v4 offset:10752
    ds_read_b128 v[112:115], v21 offset:4096
    v_mfma_f32_32x32x16_bf16 v[84:99], v[120:123], v[104:107], v[84:99]
    s_cmp_lg_u32 s97, 0
    s_cbranch_scc1 k1_r37a
    ds_read_b64_tr_b16 v[136:137], v5 offset:2048
    ds_read_b64_tr_b16 v[138:139], v5 offset:2560
k1_r37a:
    s_waitcnt lgkmcnt(3)
    v_mfma_f32_32x32x16_bf16 v[36:51], v[124:127], v[108:111], v[36:51]
    s_cmp_lg_u32 s97, 0
    s_cbranch_scc1 k1_x37a
    v_lshlrev_b32 v28, 16, v132
    v_and_b32 v29, s63, v132
    v_add_f32 v156, v156, v28
    v_add_f32 v157, v157, v29
    v_lshlrev_b32 v28, 16, v133
    v_and_b32 v29, s63, v133
    v_add_f32 v156, v156, v28
    v_add_f32 v157, v157, v29
    v_lshlrev_b32 v28, 16, v134
    v_and_b32 v29, s63, v134
    v_add_f32 v156, v156, v28
    v_add_f32 v157, v157, v29
    v_lshlrev_b32 v28, 16, v135
    v_and_b32 v29, s63, v135
    v_add_f32 v156, v156, v28
    v_add_f32 v157, v157, v29
    s_branch k1_x37b
k1_x37a:
    v_mfma_f32_16x16x32_bf16 v[148:151], v[132:135], v[140:143], v[148:151]
k1_x37b:
    ds_read_b128 v[100:103], v22 offset:0
    ds_read_b64_tr_b16 v[116:117], v4 offset:4096
    s_waitcnt lgkmcnt(3)
    v_mfma_f32_32x32x16_bf16 v[52:67], v[128:131], v[108:111], v[52:67]
    ds_read_b64_tr_b16 v[118:119], v4 offset:4608
    ds_read_b64_tr_b16 v[120:121], v4 offset:12288
    s_waitcnt lgkmcnt(4)
    v_mfma_f32_32x32x16_bf16 v[68:83], v[124:127], v[112:115], v[68:83]
    ds_read_b64_tr_b16 v[122:123], v4 offset:12800
    ds_read_b128 v[104:107], v22 offset:4096
    v_mfma_f32_32x32x16_bf16 v[84:99], v[128:131], v[112:115], v[84:99]
    s_cmp_lg_u32 s97, 0
    s_cbranch_scc1 k1_r38a
    ds_read_b64_tr_b16 v[132:133], v5 offset:4096
    ds_read_b64_tr_b16 v[134:135], v5 offset:4608
    s_branch k1_r38b
k1_r38a:
    ds_read_b128 v[140:143], v12
    ds_read_b64_tr_b16 v[132:133], v5 offset:1280
    ds_read_b64_tr_b16 v[134:135], v5 offset:1440
k1_r38b:
    s_waitcnt lgkmcnt(3)
    v_mfma_f32_32x32x16_bf16 v[36:51], v[116:119], v[100:103], v[36:51]
    s_cmp_lg_u32 s97, 0
    s_cbranch_scc1 k1_x38a
    v_lshlrev_b32 v28, 16, v136
    v_and_b32 v29, s63, v136
    v_add_f32 v156, v156, v28
    v_add_f32 v157, v157, v29
    v_lshlrev_b32 v28, 16, v137
    v_and_b32 v29, s63, v137
    v_add_f32 v156, v156, v28
    v_add_f32 v157, v157, v29
    v_lshlrev_b32 v28, 16, v138
    v_and_b32 v29, s63, v138
    v_add_f32 v156, v156, v28
    v_add_f32 v157, v157, v29
    v_lshlrev_b32 v28, 16, v139
    v_and_b32 v29, s63, v139
    v_add_f32 v156, v156, v28
    v_add_f32 v157, v157, v29
    s_branch k1_x38b
k1_x38a:
k1_x38b:
    ds_read_b128 v[108:111], v23 offset:0
    ds_read_b64_tr_b16 v[124:125], v4 offset:6144
    s_waitcnt lgkmcnt(3)
    v_mfma_f32_32x32x16_bf16 v[52:67], v[120:123], v[100:103], v[52:67]
    ds_read_b64_tr_b16 v[126:127], v4 offset:6656
    ds_read_b64_tr_b16 v[128:129], v4 offset:14336
    s_waitcnt lgkmcnt(4)
    v_mfma_f32_32x32x16_bf16 v[68:83], v[116:119], v[104:107], v[68:83]
    ds_read_b64_tr_b16 v[130:131], v4 offset:14848
    ds_read_b128 v[112:115], v23 offset:4096
    v_mfma_f32_32x32x16_bf16 v[84:99], v[120:123], v[104:107], v[84:99]
    s_cmp_lg_u32 s97, 0
    s_cbranch_scc1 k1_r39a
    ds_read_b64_tr_b16 v[136:137], v5 offset:6144
    ds_read_b64_tr_b16 v[138:139], v5 offset:6656
k1_r39a:
    s_waitcnt lgkmcnt(3)
    v_mfma_f32_32x32x16_bf16 v[36:51], v[124:127], v[108:111], v[36:51]
    s_cmp_lg_u32 s97, 0
    s_cbranch_scc1 k1_x39a
    v_lshlrev_b32 v28, 16, v132
    v_and_b32 v29, s63, v132
    v_add_f32 v156, v156, v28
    v_add_f32 v157, v157, v29
    v_lshlrev_b32 v28, 16, v133
    v_and_b32 v29, s63, v133
    v_add_f32 v156, v156, v28
    v_add_f32 v157, v157, v29
    v_lshlrev_b32 v28, 16, v134
    v_and_b32 v29, s63, v134
    v_add_f32 v156, v156, v28
    v_add_f32 v157, v157, v29
    v_lshlrev_b32 v28, 16, v135
    v_and_b32 v29, s63, v135
    v_add_f32 v156, v156, v28
    v_add_f32 v157, v157, v29
    s_branch k1_x39b
k1_x39a:
    v_mfma_f32_16x16x32_bf16 v[148:151], v[132:135], v[140:143], v[148:151]
k1_x39b:
    s_waitcnt lgkmcnt(1)
    v_mfma_f32_32x32x16_bf16 v[52:67], v[128:131], v[108:111], v[52:67]
    s_waitcnt lgkmcnt(0)
    v_mfma_f32_32x32x16_bf16 v[68:83], v[124:127], v[112:115], v[68:83]
    v_mfma_f32_32x32x16_bf16 v[84:99], v[128:131], v[112:115], v[84:99]
    s_waitcnt lgkmcnt(0)
    s_and_b32 s17, s14, 1
    s_lshl_b32 s17, s17, 6
    s_add_u32 s17, s17, 160384
    v_lshlrev_b32 v8, 4, v14
    v_add_u32 v8, s17, v8
    s_cmp_lg_u32 s97, 0
    s_cbranch_scc1 k1_e1
    v_lshlrev_b32 v28, 16, v136
    v_and_b32 v29, s63, v136
    v_add_f32 v156, v156, v28
    v_add_f32 v157, v157, v29
    v_lshlrev_b32 v28, 16, v137
    v_and_b32 v29, s63, v137
    v_add_f32 v156, v156, v28
    v_add_f32 v157, v157, v29
    v_lshlrev_b32 v28, 16, v138
    v_and_b32 v29, s63, v138
    v_add_f32 v156, v156, v28
    v_add_f32 v157, v157, v29
    v_lshlrev_b32 v28, 16, v139
    v_and_b32 v29, s63, v139
    v_add_f32 v156, v156, v28
    v_add_f32 v157, v157, v29
    v_add_f32 v156, v156, v157
    v_mov_b32 v6, v156
    s_nop 1
    v_permlane32_swap_b32 v156, v6
    v_add_f32 v156, v156, v6
    v_and_b32 v6, 31, v1
    v_lshlrev_b32 v6, 2, v6
    s_lshl_b32 s17, s14, 7
    s_add_u32 s17, s17, 159744
    v_add_u32 v6, s17, v6
    ds_write_b32 v6, v156
    s_branch k1_e2
k1_e1:
    s_cmp_lt_u32 s96, 2
    s_cbranch_scc1 k1_e2
    s_nop 7
    ds_write_b128 v8, v[148:151]
k1_e2:
    v_lshrrev_b32 v7, 5, v1
    v_lshlrev_b32 v7, 4, v7
    s_lshl_b32 s17, s97, 7
    s_add_u32 s17, s17, 159744
    v_add_u32 v7, s17, v7
    s_waitcnt lgkmcnt(0)
    s_barrier
    ds_read_b128 v[152:155], v8
    ds_read_b128 v[100:103], v7 offset:0
    ds_read_b128 v[104:107], v7 offset:32
    ds_read_b128 v[108:111], v7 offset:64
    ds_read_b128 v[112:115], v7 offset:96
    ds_read_b128 v[116:119], v7 offset:256
    ds_read_b128 v[120:123], v7 offset:288
    ds_read_b128 v[124:127], v7 offset:320
    ds_read_b128 v[128:131], v7 offset:352
    v_bfe_u32 v6, v1, 4, 1
    v_mul_u32_u24 v10, 75776, v6
    v_lshl_add_u32 v10, v13, 4, v10
    v_lshrrev_b32 v6, 5, v1
    v_lshl_add_u32 v10, v6, 8, v10
    s_lshl_b32 s17, s15, 3
    s_lshl_b32 s19, s96, 1
    s_add_u32 s17, s17, s19
    s_mul_i32 s28, s17, 151552
    s_lshl_b32 s19, s16, 11
    s_add_u32 s28, s28, s19
    s_lshl_b32 s19, s97, 10
    s_add_u32 s28, s28, s19
    s_add_u32 s28, s28, 8409088
    s_add_u32 s29, s28, 151552
    s_mov_b32 s34, 0xbfb8aa3b
    s_waitcnt vmcnt(0) lgkmcnt(0)
    v_sub_f32 v164, 0, v158
    v_sub_f32 v166, 0, v160
    s_cmp_ge_u32 s16, 27
    s_cbranch_scc1 k1_qepi
    v_mul_f32 v28, s34, v159
    v_mul_f32 v32, v159, v159
    v_rcp_f32 v32, v32
    v_mul_f32 v30, s34, v161
    v_mul_f32 v34, v161, v161
    v_rcp_f32 v34, v34
    v_pk_fma_f32 v[36:37], v[100:101], v[164:165], v[36:37] op_sel_hi:[1,0,1]
    v_pk_fma_f32 v[38:39], v[102:103], v[164:165], v[38:39] op_sel_hi:[1,0,1]
    v_pk_fma_f32 v[40:41], v[104:105], v[164:165], v[40:41] op_sel_hi:[1,0,1]
    v_pk_fma_f32 v[42:43], v[106:107], v[164:165], v[42:43] op_sel_hi:[1,0,1]
    v_pk_fma_f32 v[44:45], v[108:109], v[164:165], v[44:45] op_sel_hi:[1,0,1]
    v_pk_fma_f32 v[46:47], v[110:111], v[164:165], v[46:47] op_sel_hi:[1,0,1]
    v_pk_fma_f32 v[48:49], v[112:113], v[164:165], v[48:49] op_sel_hi:[1,0,1]
    v_pk_fma_f32 v[50:51], v[114:115], v[164:165], v[50:51] op_sel_hi:[1,0,1]
    v_pk_fma_f32 v[52:53], v[116:117], v[164:165], v[52:53] op_sel_hi:[1,0,1]
    v_pk_fma_f32 v[54:55], v[118:119], v[164:165], v[54:55] op_sel_hi:[1,0,1]
    v_pk_fma_f32 v[56:57], v[120:121], v[164:165], v[56:57] op_sel_hi:[1,0,1]
    v_pk_fma_f32 v[58:59], v[122:123], v[164:165], v[58:59] op_sel_hi:[1,0,1]
    v_pk_fma_f32 v[60:61], v[124:125], v[164:165], v[60:61] op_sel_hi:[1,0,1]
    v_pk_fma_f32 v[62:63], v[126:127], v[164:165], v[62:63] op_sel_hi:[1,0,1]
    v_pk_fma_f32 v[64:65], v[128:129], v[164:165], v[64:65] op_sel_hi:[1,0,1]
    v_pk_fma_f32 v[66:67], v[130:131], v[164:165], v[66:67] op_sel_hi:[1,0,1]
    v_pk_mul_f32 v[132:133], v[36:37], v[28:29] op_sel_hi:[1,0]
    v_pk_mul_f32 v[134:135], v[38:39], v[28:29] op_sel_hi:[1,0]
    v_pk_mul_f32 v[136:137], v[40:41], v[28:29] op_sel_hi:[1,0]
    v_pk_mul_f32 v[138:139], v[42:43], v[28:29] op_sel_hi:[1,0]
    v_pk_mul_f32 v[140:141], v[44:45], v[28:29] op_sel_hi:[1,0]
    v_pk_mul_f32 v[142:143], v[46:47], v[28:29] op_sel_hi:[1,0]
    v_pk_mul_f32 v[144:145], v[48:49], v[28:29] op_sel_hi:[1,0]
    v_pk_mul_f32 v[146:147], v[50:51], v[28:29] op_sel_hi:[1,0]
    v_exp_f32 v132, v132
    v_exp_f32 v133, v133
    v_exp_f32 v134, v134
    v_exp_f32 v135, v135
    v_exp_f32 v136, v136
    v_exp_f32 v137, v137
    v_exp_f32 v138, v138
    v_exp_f32 v139, v139
    v_exp_f32 v140, v140
    v_exp_f32 v141, v141
    v_exp_f32 v142, v142
    v_exp_f32 v143, v143
    v_exp_f32 v144, v144
    v_exp_f32 v145, v145
    v_exp_f32 v146, v146
    v_exp_f32 v147, v147
    v_pk_mul_f32 v[36:37], v[36:37], v[52:53]
    v_pk_fma_f32 v[132:133], v[132:133], v[32:33], v[32:33] op_sel_hi:[1,0,0]
    v_pk_mul_f32 v[38:39], v[38:39], v[54:55]
    v_pk_fma_f32 v[134:135], v[134:135], v[32:33], v[32:33] op_sel_hi:[1,0,0]
    v_pk_mul_f32 v[40:41], v[40:41], v[56:57]
    v_pk_fma_f32 v[136:137], v[136:137], v[32:33], v[32:33] op_sel_hi:[1,0,0]
    v_pk_mul_f32 v[42:43], v[42:43], v[58:59]
    v_pk_fma_f32 v[138:139], v[138:139], v[32:33], v[32:33] op_sel_hi:[1,0,0]
    v_pk_mul_f32 v[44:45], v[44:45], v[60:61]
    v_pk_fma_f32 v[140:141], v[140:141], v[32:33], v[32:33] op_sel_hi:[1,0,0]
    v_pk_mul_f32 v[46:47], v[46:47], v[62:63]
    v_pk_fma_f32 v[142:143], v[142:143], v[32:33], v[32:33] op_sel_hi:[1,0,0]
    v_pk_mul_f32 v[48:49], v[48:49], v[64:65]
    v_pk_fma_f32 v[144:145], v[144:145], v[32:33], v[32:33] op_sel_hi:[1,0,0]
    v_pk_mul_f32 v[50:51], v[50:51], v[66:67]
    v_pk_fma_f32 v[146:147], v[146:147], v[32:33], v[32:33] op_sel_hi:[1,0,0]
    v_rcp_f32 v132, v132
    v_rcp_f32 v133, v133
    v_rcp_f32 v134, v134
    v_rcp_f32 v135, v135
    v_rcp_f32 v136, v136
    v_rcp_f32 v137, v137
    v_rcp_f32 v138, v138
    v_rcp_f32 v139, v139
    v_rcp_f32 v140, v140
    v_rcp_f32 v141, v141
    v_rcp_f32 v142, v142
    v_rcp_f32 v143, v143
    v_rcp_f32 v144, v144
    v_rcp_f32 v145, v145
    v_rcp_f32 v146, v146
    v_rcp_f32 v147, v147
    v_pk_mul_f32 v[36:37], v[36:37], v[132:133]
    v_pk_mul_f32 v[38:39], v[38:39], v[134:135]
    v_pk_mul_f32 v[40:41], v[40:41], v[136:137]
    v_pk_mul_f32 v[42:43], v[42:43], v[138:139]
    v_pk_mul_f32 v[44:45], v[44:45], v[140:141]
    v_pk_mul_f32 v[46:47], v[46:47], v[142:143]
    v_pk_mul_f32 v[48:49], v[48:49], v[144:145]
    v_pk_mul_f32 v[50:51], v[50:51], v[146:147]
    v_cvt_pk_bf16_f32 v52, v36, v37
    v_cvt_pk_bf16_f32 v53, v38, v39
    v_cvt_pk_bf16_f32 v54, v40, v41
    v_cvt_pk_bf16_f32 v55, v42, v43
    v_cvt_pk_bf16_f32 v56, v44, v45
    v_cvt_pk_bf16_f32 v57, v46, v47
    v_cvt_pk_bf16_f32 v58, v48, v49
    v_cvt_pk_bf16_f32 v59, v50, v51
    v_permlane32_swap_b32 v52, v54
    v_permlane32_swap_b32 v53, v55
    v_permlane32_swap_b32 v56, v58
    v_permlane32_swap_b32 v57, v59
    buffer_store_dwordx4 v[52:55], v10, s[44:47], s28 offen offset:0
    buffer_store_dwordx4 v[56:59], v10, s[44:47], s28 offen offset:512
    v_pk_fma_f32 v[68:69], v[100:101], v[166:167], v[68:69] op_sel_hi:[1,0,1]
    v_pk_fma_f32 v[70:71], v[102:103], v[166:167], v[70:71] op_sel_hi:[1,0,1]
    v_pk_fma_f32 v[72:73], v[104:105], v[166:167], v[72:73] op_sel_hi:[1,0,1]
    v_pk_fma_f32 v[74:75], v[106:107], v[166:167], v[74:75] op_sel_hi:[1,0,1]
    v_pk_fma_f32 v[76:77], v[108:109], v[166:167], v[76:77] op_sel_hi:[1,0,1]
    v_pk_fma_f32 v[78:79], v[110:111], v[166:167], v[78:79] op_sel_hi:[1,0,1]
    v_pk_fma_f32 v[80:81], v[112:113], v[166:167], v[80:81] op_sel_hi:[1,0,1]
    v_pk_fma_f32 v[82:83], v[114:115], v[166:167], v[82:83] op_sel_hi:[1,0,1]
    v_pk_fma_f32 v[84:85], v[116:117], v[166:167], v[84:85] op_sel_hi:[1,0,1]
    v_pk_fma_f32 v[86:87], v[118:119], v[166:167], v[86:87] op_sel_hi:[1,0,1]
    v_pk_fma_f32 v[88:89], v[120:121], v[166:167], v[88:89] op_sel_hi:[1,0,1]
    v_pk_fma_f32 v[90:91], v[122:123], v[166:167], v[90:91] op_sel_hi:[1,0,1]
    v_pk_fma_f32 v[92:93], v[124:125], v[166:167], v[92:93] op_sel_hi:[1,0,1]
    v_pk_fma_f32 v[94:95], v[126:127], v[166:167], v[94:95] op_sel_hi:[1,0,1]
    v_pk_fma_f32 v[96:97], v[128:129], v[166:167], v[96:97] op_sel_hi:[1,0,1]
    v_pk_fma_f32 v[98:99], v[130:131], v[166:167], v[98:99] op_sel_hi:[1,0,1]
    v_pk_mul_f32 v[132:133], v[68:69], v[30:31] op_sel_hi:[1,0]
    v_pk_mul_f32 v[134:135], v[70:71], v[30:31] op_sel_hi:[1,0]
    v_pk_mul_f32 v[136:137], v[72:73], v[30:31] op_sel_hi:[1,0]
    v_pk_mul_f32 v[138:139], v[74:75], v[30:31] op_sel_hi:[1,0]
    v_pk_mul_f32 v[140:141], v[76:77], v[30:31] op_sel_hi:[1,0]
    v_pk_mul_f32 v[142:143], v[78:79], v[30:31] op_sel_hi:[1,0]
    v_pk_mul_f32 v[144:145], v[80:81], v[30:31] op_sel_hi:[1,0]
    v_pk_mul_f32 v[146:147], v[82:83], v[30:31] op_sel_hi:[1,0]
    v_exp_f32 v132, v132
    v_exp_f32 v133, v133
    v_exp_f32 v134, v134
    v_exp_f32 v135, v135
    v_exp_f32 v136, v136
    v_exp_f32 v137, v137
    v_exp_f32 v138, v138
    v_exp_f32 v139, v139
    v_exp_f32 v140, v140
    v_exp_f32 v141, v141
    v_exp_f32 v142, v142
    v_exp_f32 v143, v143
    v_exp_f32 v144, v144
    v_exp_f32 v145, v145
    v_exp_f32 v146, v146
    v_exp_f32 v147, v147
    v_pk_mul_f32 v[68:69], v[68:69], v[84:85]
    v_pk_fma_f32 v[132:133], v[132:133], v[34:35], v[34:35] op_sel_hi:[1,0,0]
    v_pk_mul_f32 v[70:71], v[70:71], v[86:87]
    v_pk_fma_f32 v[134:135], v[134:135], v[34:35], v[34:35] op_sel_hi:[1,0,0]
    v_pk_mul_f32 v[72:73], v[72:73], v[88:89]
    v_pk_fma_f32 v[136:137], v[136:137], v[34:35], v[34:35] op_sel_hi:[1,0,0]
    v_pk_mul_f32 v[74:75], v[74:75], v[90:91]
    v_pk_fma_f32 v[138:139], v[138:139], v[34:35], v[34:35] op_sel_hi:[1,0,0]
    v_pk_mul_f32 v[76:77], v[76:77], v[92:93]
    v_pk_fma_f32 v[140:141], v[140:141], v[34:35], v[34:35] op_sel_hi:[1,0,0]
    v_pk_mul_f32 v[78:79], v[78:79], v[94:95]
    v_pk_fma_f32 v[142:143], v[142:143], v[34:35], v[34:35] op_sel_hi:[1,0,0]
    v_pk_mul_f32 v[80:81], v[80:81], v[96:97]
    v_pk_fma_f32 v[144:145], v[144:145], v[34:35], v[34:35] op_sel_hi:[1,0,0]
    v_pk_mul_f32 v[82:83], v[82:83], v[98:99]
    v_pk_fma_f32 v[146:147], v[146:147], v[34:35], v[34:35] op_sel_hi:[1,0,0]
    v_rcp_f32 v132, v132
    v_rcp_f32 v133, v133
    v_rcp_f32 v134, v134
    v_rcp_f32 v135, v135
    v_rcp_f32 v136, v136
    v_rcp_f32 v137, v137
    v_rcp_f32 v138, v138
    v_rcp_f32 v139, v139
    v_rcp_f32 v140, v140
    v_rcp_f32 v141, v141
    v_rcp_f32 v142, v142
    v_rcp_f32 v143, v143
    v_rcp_f32 v144, v144
    v_rcp_f32 v145, v145
    v_rcp_f32 v146, v146
    v_rcp_f32 v147, v147
    v_pk_mul_f32 v[68:69], v[68:69], v[132:133]
    v_pk_mul_f32 v[70:71], v[70:71], v[134:135]
    v_pk_mul_f32 v[72:73], v[72:73], v[136:137]
    v_pk_mul_f32 v[74:75], v[74:75], v[138:139]
    v_pk_mul_f32 v[76:77], v[76:77], v[140:141]
    v_pk_mul_f32 v[78:79], v[78:79], v[142:143]
    v_pk_mul_f32 v[80:81], v[80:81], v[144:145]
    v_pk_mul_f32 v[82:83], v[82:83], v[146:147]
    v_cvt_pk_bf16_f32 v84, v68, v69
    v_cvt_pk_bf16_f32 v85, v70, v71
    v_cvt_pk_bf16_f32 v86, v72, v73
    v_cvt_pk_bf16_f32 v87, v74, v75
    v_cvt_pk_bf16_f32 v88, v76, v77
    v_cvt_pk_bf16_f32 v89, v78, v79
    v_cvt_pk_bf16_f32 v90, v80, v81
    v_cvt_pk_bf16_f32 v91, v82, v83
    v_permlane32_swap_b32 v84, v86
    v_permlane32_swap_b32 v85, v87
    v_permlane32_swap_b32 v88, v90
    v_permlane32_swap_b32 v89, v91
    buffer_store_dwordx4 v[84:87], v10, s[44:47], s29 offen offset:0
    buffer_store_dwordx4 v[88:91], v10, s[44:47], s29 offen offset:512
    s_branch k1_kvepi
k1_qepi:
    v_and_b32 v6, 31, v1
    v_mul_u32_u24 v10, 1280, v6
    v_lshrrev_b32 v6, 5, v1
    v_lshl_add_u32 v10, v6, 4, v10
    s_mul_i32 s28, s17, 40960
    s_sub_u32 s19, s16, 27
    s_lshl_b32 s19, s19, 8
    s_add_u32 s28, s28, s19
    s_lshl_b32 s19, s97, 6
    s_add_u32 s28, s28, s19
    s_add_u32 s28, s28, 3145728
    s_add_u32 s29, s28, 40960
    v_mul_f32 v28, 0x3ea52b5c, v159
    v_mul_f32 v30, 0x3ea52b5c, v161
    v_pk_fma_f32 v[36:37], v[100:101], v[164:165], v[36:37] op_sel_hi:[1,0,1]
    v_pk_fma_f32 v[38:39], v[102:103], v[164:165], v[38:39] op_sel_hi:[1,0,1]
    v_pk_fma_f32 v[40:41], v[104:105], v[164:165], v[40:41] op_sel_hi:[1,0,1]
    v_pk_fma_f32 v[42:43], v[106:107], v[164:165], v[42:43] op_sel_hi:[1,0,1]
    v_pk_fma_f32 v[44:45], v[108:109], v[164:165], v[44:45] op_sel_hi:[1,0,1]
    v_pk_fma_f32 v[46:47], v[110:111], v[164:165], v[46:47] op_sel_hi:[1,0,1]
    v_pk_fma_f32 v[48:49], v[112:113], v[164:165], v[48:49] op_sel_hi:[1,0,1]
    v_pk_fma_f32 v[50:51], v[114:115], v[164:165], v[50:51] op_sel_hi:[1,0,1]
    v_pk_mul_f32 v[36:37], v[36:37], v[28:29] op_sel_hi:[1,0]
    v_pk_mul_f32 v[38:39], v[38:39], v[28:29] op_sel_hi:[1,0]
    v_pk_mul_f32 v[40:41], v[40:41], v[28:29] op_sel_hi:[1,0]
    v_pk_mul_f32 v[42:43], v[42:43], v[28:29] op_sel_hi:[1,0]
    v_pk_mul_f32 v[44:45], v[44:45], v[28:29] op_sel_hi:[1,0]
    v_pk_mul_f32 v[46:47], v[46:47], v[28:29] op_sel_hi:[1,0]
    v_pk_mul_f32 v[48:49], v[48:49], v[28:29] op_sel_hi:[1,0]
    v_pk_mul_f32 v[50:51], v[50:51], v[28:29] op_sel_hi:[1,0]
    v_cvt_pk_bf16_f32 v36, v36, v37
    v_cvt_pk_bf16_f32 v37, v38, v39
    v_cvt_pk_bf16_f32 v38, v40, v41
    v_cvt_pk_bf16_f32 v39, v42, v43
    v_cvt_pk_bf16_f32 v40, v44, v45
    v_cvt_pk_bf16_f32 v41, v46, v47
    v_cvt_pk_bf16_f32 v42, v48, v49
    v_cvt_pk_bf16_f32 v43, v50, v51
    v_permlane32_swap_b32 v36, v38
    v_permlane32_swap_b32 v37, v39
    v_permlane32_swap_b32 v40, v42
    v_permlane32_swap_b32 v41, v43
    buffer_store_dwordx4 v[36:39], v10, s[44:47], s28 offen offset:0
    buffer_store_dwordx4 v[40:43], v10, s[44:47], s28 offen offset:32
    v_pk_fma_f32 v[52:53], v[116:117], v[164:165], v[52:53] op_sel_hi:[1,0,1]
    v_pk_fma_f32 v[54:55], v[118:119], v[164:165], v[54:55] op_sel_hi:[1,0,1]
    v_pk_fma_f32 v[56:57], v[120:121], v[164:165], v[56:57] op_sel_hi:[1,0,1]
    v_pk_fma_f32 v[58:59], v[122:123], v[164:165], v[58:59] op_sel_hi:[1,0,1]
    v_pk_fma_f32 v[60:61], v[124:125], v[164:165], v[60:61] op_sel_hi:[1,0,1]
    v_pk_fma_f32 v[62:63], v[126:127], v[164:165], v[62:63] op_sel_hi:[1,0,1]
    v_pk_fma_f32 v[64:65], v[128:129], v[164:165], v[64:65] op_sel_hi:[1,0,1]
    v_pk_fma_f32 v[66:67], v[130:131], v[164:165], v[66:67] op_sel_hi:[1,0,1]
    v_pk_mul_f32 v[52:53], v[52:53], v[28:29] op_sel_hi:[1,0]
    v_pk_mul_f32 v[54:55], v[54:55], v[28:29] op_sel_hi:[1,0]
    v_pk_mul_f32 v[56:57], v[56:57], v[28:29] op_sel_hi:[1,0]
    v_pk_mul_f32 v[58:59], v[58:59], v[28:29] op_sel_hi:[1,0]
    v_pk_mul_f32 v[60:61], v[60:61], v[28:29] op_sel_hi:[1,0]
    v_pk_mul_f32 v[62:63], v[62:63], v[28:29] op_sel_hi:[1,0]
    v_pk_mul_f32 v[64:65], v[64:65], v[28:29] op_sel_hi:[1,0]
    v_pk_mul_f32 v[66:67], v[66:67], v[28:29] op_sel_hi:[1,0]
    v_cvt_pk_bf16_f32 v52, v52, v53
    v_cvt_pk_bf16_f32 v53, v54, v55
    v_cvt_pk_bf16_f32 v54, v56, v57
    v_cvt_pk_bf16_f32 v55, v58, v59
    v_cvt_pk_bf16_f32 v56, v60, v61
    v_cvt_pk_bf16_f32 v57, v62, v63
    v_cvt_pk_bf16_f32 v58, v64, v65
    v_cvt_pk_bf16_f32 v59, v66, v67
    v_permlane32_swap_b32 v52, v54
    v_permlane32_swap_b32 v53, v55
    v_permlane32_swap_b32 v56, v58
    v_permlane32_swap_b32 v57, v59
    buffer_store_dwordx4 v[52:55], v10, s[44:47], s28 offen offset:128
    buffer_store_dwordx4 v[56:59], v10, s[44:47], s28 offen offset:160
    v_pk_fma_f32 v[68:69], v[100:101], v[166:167], v[68:69] op_sel_hi:[1,0,1]
    v_pk_fma_f32 v[70:71], v[102:103], v[166:167], v[70:71] op_sel_hi:[1,0,1]
    v_pk_fma_f32 v[72:73], v[104:105], v[166:167], v[72:73] op_sel_hi:[1,0,1]
    v_pk_fma_f32 v[74:75], v[106:107], v[166:167], v[74:75] op_sel_hi:[1,0,1]
    v_pk_fma_f32 v[76:77], v[108:109], v[166:167], v[76:77] op_sel_hi:[1,0,1]
    v_pk_fma_f32 v[78:79], v[110:111], v[166:167], v[78:79] op_sel_hi:[1,0,1]
    v_pk_fma_f32 v[80:81], v[112:113], v[166:167], v[80:81] op_sel_hi:[1,0,1]
    v_pk_fma_f32 v[82:83], v[114:115], v[166:167], v[82:83] op_sel_hi:[1,0,1]
    v_pk_mul_f32 v[68:69], v[68:69], v[30:31] op_sel_hi:[1,0]
    v_pk_mul_f32 v[70:71], v[70:71], v[30:31] op_sel_hi:[1,0]
    v_pk_mul_f32 v[72:73], v[72:73], v[30:31] op_sel_hi:[1,0]
    v_pk_mul_f32 v[74:75], v[74:75], v[30:31] op_sel_hi:[1,0]
    v_pk_mul_f32 v[76:77], v[76:77], v[30:31] op_sel_hi:[1,0]
    v_pk_mul_f32 v[78:79], v[78:79], v[30:31] op_sel_hi:[1,0]
    v_pk_mul_f32 v[80:81], v[80:81], v[30:31] op_sel_hi:[1,0]
    v_pk_mul_f32 v[82:83], v[82:83], v[30:31] op_sel_hi:[1,0]
    v_cvt_pk_bf16_f32 v68, v68, v69
    v_cvt_pk_bf16_f32 v69, v70, v71
    v_cvt_pk_bf16_f32 v70, v72, v73
    v_cvt_pk_bf16_f32 v71, v74, v75
    v_cvt_pk_bf16_f32 v72, v76, v77
    v_cvt_pk_bf16_f32 v73, v78, v79
    v_cvt_pk_bf16_f32 v74, v80, v81
    v_cvt_pk_bf16_f32 v75, v82, v83
    v_permlane32_swap_b32 v68, v70
    v_permlane32_swap_b32 v69, v71
    v_permlane32_swap_b32 v72, v74
    v_permlane32_swap_b32 v73, v75
    buffer_store_dwordx4 v[68:71], v10, s[44:47], s29 offen offset:0
    buffer_store_dwordx4 v[72:75], v10, s[44:47], s29 offen offset:32
    v_pk_fma_f32 v[84:85], v[116:117], v[166:167], v[84:85] op_sel_hi:[1,0,1]
    v_pk_fma_f32 v[86:87], v[118:119], v[166:167], v[86:87] op_sel_hi:[1,0,1]
    v_pk_fma_f32 v[88:89], v[120:121], v[166:167], v[88:89] op_sel_hi:[1,0,1]
    v_pk_fma_f32 v[90:91], v[122:123], v[166:167], v[90:91] op_sel_hi:[1,0,1]
    v_pk_fma_f32 v[92:93], v[124:125], v[166:167], v[92:93] op_sel_hi:[1,0,1]
    v_pk_fma_f32 v[94:95], v[126:127], v[166:167], v[94:95] op_sel_hi:[1,0,1]
    v_pk_fma_f32 v[96:97], v[128:129], v[166:167], v[96:97] op_sel_hi:[1,0,1]
    v_pk_fma_f32 v[98:99], v[130:131], v[166:167], v[98:99] op_sel_hi:[1,0,1]
    v_pk_mul_f32 v[84:85], v[84:85], v[30:31] op_sel_hi:[1,0]
    v_pk_mul_f32 v[86:87], v[86:87], v[30:31] op_sel_hi:[1,0]
    v_pk_mul_f32 v[88:89], v[88:89], v[30:31] op_sel_hi:[1,0]
    v_pk_mul_f32 v[90:91], v[90:91], v[30:31] op_sel_hi:[1,0]
    v_pk_mul_f32 v[92:93], v[92:93], v[30:31] op_sel_hi:[1,0]
    v_pk_mul_f32 v[94:95], v[94:95], v[30:31] op_sel_hi:[1,0]
    v_pk_mul_f32 v[96:97], v[96:97], v[30:31] op_sel_hi:[1,0]
    v_pk_mul_f32 v[98:99], v[98:99], v[30:31] op_sel_hi:[1,0]
    v_cvt_pk_bf16_f32 v84, v84, v85
    v_cvt_pk_bf16_f32 v85, v86, v87
    v_cvt_pk_bf16_f32 v86, v88, v89
    v_cvt_pk_bf16_f32 v87, v90, v91
    v_cvt_pk_bf16_f32 v88, v92, v93
    v_cvt_pk_bf16_f32 v89, v94, v95
    v_cvt_pk_bf16_f32 v90, v96, v97
    v_cvt_pk_bf16_f32 v91, v98, v99
    v_permlane32_swap_b32 v84, v86
    v_permlane32_swap_b32 v85, v87
    v_permlane32_swap_b32 v88, v90
    v_permlane32_swap_b32 v89, v91
    buffer_store_dwordx4 v[84:87], v10, s[44:47], s29 offen offset:128
    buffer_store_dwordx4 v[88:91], v10, s[44:47], s29 offen offset:160
k1_kvepi:
    s_sub_u32 s99, s14, 4
    s_cmp_ge_u32 s99, 2
    s_cbranch_scc1 k1_done
    v_fma_f32 v148, -v162, v152, v148
    v_mul_f32 v148, v148, v163
    v_fma_f32 v149, -v162, v153, v149
    v_mul_f32 v149, v149, v163
    v_fma_f32 v150, -v162, v154, v150
    v_mul_f32 v150, v150, v163
    v_fma_f32 v151, -v162, v155, v151
    v_mul_f32 v151, v151, v163
    s_lshl_b32 s28, s15, 3
    s_lshr_b32 s17, s62, 1
    s_add_u32 s28, s28, s17
    s_and_b32 s17, s28, 28
    s_lshl_b32 s17, s17, 1
    s_lshr_b32 s19, s28, 5
    s_lshl_b32 s19, s19, 2
    s_add_u32 s17, s17, s19
    s_and_b32 s28, s28, 3
    s_add_u32 s28, s28, s17
    s_mul_i32 s28, s28, 2688
    s_add_u32 s28, s28, 6291456
    s_mov_b64 s[34:35], -1
    s_mov_b64 s[50:51], -1
    s_cmp_eq_u32 s99, 0
    s_cbranch_scc1 k1_nopad
    s_mov_b64 s[34:35], 0xffff
    s_mov_b32 s51, 0
    v_cndmask_b32 v148, 1.0, v148, s[34:35]
    v_cndmask_b32 v149, 0, v149, s[34:35]
k1_nopad:
    v_cvt_pk_bf16_f32 v152, v148, v149
    v_cvt_pk_bf16_f32 v153, v150, v151
    s_and_b32 s17, s62, 1
    s_and_b32 s19, s16, 1
    s_cmp_eq_u32 s19, 0
    s_cbranch_scc0 k1_vstore
    s_lshl_b32 s17, s17, 4
    v_add_u32 v8, s17, v13
    v_lshrrev_b32 v6, 1, v14
    v_lshlrev_b32 v6, 9, v6
    v_and_b32 v7, 1, v14
    v_lshl_add_u32 v6, v7, 3, v6
    v_lshl_add_u32 v6, v8, 4, v6
    v_lshlrev_b32 v7, 3, v8
    v_add_u32 v7, 1024, v7
    s_cmp_eq_u32 s99, 0
    s_cselect_b64 vcc, -1, 0
    v_cndmask_b32 v6, v7, v6, vcc
    s_mov_b64 exec, s[34:35]
    buffer_store_dwordx2 v[152:153], v6, s[44:47], s28 offen
    s_branch k1_done
k1_vstore:
    s_mul_i32 s17, s17, 704
    s_lshl_b32 s19, s99, 8
    s_add_u32 s17, s17, s19
    s_add_u32 s17, s17, 1280
    v_bfe_u32 v6, v13, 2, 1
    v_mul_u32_u24 v6, 352, v6
    v_lshrrev_b32 v7, 3, v13
    v_lshl_add_u32 v6, v7, 3, v6
    v_and_b32 v7, 3, v13
    v_lshl_add_u32 v6, v7, 1, v6
    v_lshl_add_u32 v6, v14, 6, v6
    v_add_u32 v6, s17, v6
    s_mov_b64 exec, s[50:51]
    buffer_store_short v152, v6, s[44:47], s28 offen
    buffer_store_short_d16_hi v152, v6, s[44:47], s28 offen offset:16
    s_mov_b64 exec, s[34:35]
    buffer_store_short v153, v6, s[44:47], s28 offen offset:32
    buffer_store_short_d16_hi v153, v6, s[44:47], s28 offen offset:48
k1_done:
    s_mov_b64 exec, -1
k1_exit:
    s_endpgm

.section .rodata,"a"
.p2align 6
.amdhsa_kernel gemm1_kernel
  .amdhsa_next_free_vgpr 168
  .amdhsa_next_free_sgpr 100
  .amdhsa_accum_offset 168
  .amdhsa_group_segment_fixed_size 0
  .amdhsa_kernarg_size 96
  .amdhsa_user_sgpr_count 2
  .amdhsa_user_sgpr_kernarg_segment_ptr 1
  .amdhsa_system_sgpr_workgroup_id_x 1
.end_amdhsa_kernel
.text
.globl k2_kernel
.p2align 8
.type k2_kernel,@function
k2_kernel:
    s_cmp_ge_u32 s2, 512
    s_cbranch_scc1 k2_exit
    s_cmp_ge_u32 s2, 256
    s_cbranch_scc1 k2_gemm
    s_and_b32 s3, s2, 7
    s_lshl_b32 s3, s3, 5
    s_lshr_b32 s4, s2, 3
    s_add_u32 s3, s3, s4
    s_setprio 1
    s_load_dwordx2 s[4:5], s[0:1], 88
    v_and_b32 v1, 63, v0
    v_lshrrev_b32 v15, 6, v0
    v_lshlrev_b32 v2, 4, v1
    v_readfirstlane_b32 s6, v15
    v_and_b32 v15, 31, v1
    v_lshrrev_b32 v16, 5, v1
    v_mul_u32_u24 v4, 40, v15
    v_lshl_add_u32 v3, v16, 4, v4
    v_add_u32 v4, 32, v4
    s_and_b32 s24, s6, 1
    s_lshr_b32 s25, s6, 1
    s_lshl_b32 s9, s3, 3
    s_lshl_b32 s10, s24, 2
    s_add_u32 s9, s9, s10
    s_lshl_b32 s10, s25, 1
    s_add_u32 s11, s9, s10
    s_sub_u32 s17, s9, s10
    s_add_u32 s17, s17, 2
    s_mul_i32 s18, s11, 1280
    s_mul_i32 s19, s17, 1280
    s_add_u32 s18, s18, 3145728
    s_add_u32 s19, s19, 3145728
    s_mul_i32 s7, s6, 5120
    s_add_u32 s8, s7, 6291456
    s_mov_b32 s26, 0
    s_waitcnt lgkmcnt(0)
    s_mov_b32 s20, s4
    s_mov_b32 s21, s5
    s_mov_b32 s22, 67108864
    s_mov_b32 s23, 0x00020000
    v_lshlrev_b32 v9, 3, v15
    v_add_u32 v9, 1024, v9
    v_mov_b32 v8, 1616
    v_cmp_gt_u32 vcc, 32, v1
    s_nop 1
    v_cndmask_b32 v9, v8, v9, vcc
    v_min_u32 v10, 21, v15
    v_lshlrev_b32 v10, 4, v10
    v_mul_u32_u24 v8, 352, v16
    v_add_u32 v10, v10, v8
    v_add_u32 v10, 1280, v10
    s_mul_i32 s8, s25, 10752
    s_add_u32 s8, s8, 6291456
    s_mov_b32 s16, 6291456
    buffer_load_dwordx4 v[24:27], v3, s[20:23], s18 offen offset:0
    buffer_load_dwordx2 v[28:29], v4, s[20:23], s18 offen offset:0
    buffer_load_dwordx4 v[32:35], v3, s[20:23], s18 offen offset:1280
    buffer_load_dwordx2 v[36:37], v4, s[20:23], s18 offen offset:1280
    buffer_load_dwordx4 v[40:43], v3, s[20:23], s19 offen offset:0
    buffer_load_dwordx2 v[44:45], v4, s[20:23], s19 offen offset:0
    buffer_load_dwordx4 v[48:51], v3, s[20:23], s19 offen offset:1280
    buffer_load_dwordx2 v[52:53], v4, s[20:23], s19 offen offset:1280
    buffer_load_dwordx4 v[80:83], v2, s[20:23], s16 offen
    buffer_load_dwordx2 v[84:85], v9, s[20:23], s16 offen
    buffer_load_dwordx4 v[112:115], v2, s[20:23], s16 offen offset:2688
    buffer_load_dwordx2 v[116:117], v9, s[20:23], s16 offen offset:2688
    s_mov_b32 s14, s8
    buffer_load_dwordx4 v[56:59], v2, s[20:23], s14 offen
    buffer_load_dwordx2 v[60:61], v9, s[20:23], s14 offen
    buffer_load_dwordx4 v[88:91], v10, s[20:23], s14 offen
    buffer_load_dwordx4 v[92:95], v10, s[20:23], s14 offen offset:704
    s_add_u32 s14, s14, 2688
    buffer_load_dwordx4 v[64:67], v2, s[20:23], s14 offen
    buffer_load_dwordx2 v[68:69], v9, s[20:23], s14 offen
    buffer_load_dwordx4 v[96:99], v10, s[20:23], s14 offen
    buffer_load_dwordx4 v[100:103], v10, s[20:23], s14 offen offset:704
    s_add_u32 s14, s14, 2688
    buffer_load_dwordx4 v[72:75], v2, s[20:23], s14 offen
    buffer_load_dwordx2 v[76:77], v9, s[20:23], s14 offen
    buffer_load_dwordx4 v[104:107], v10, s[20:23], s14 offen
    buffer_load_dwordx4 v[108:111], v10, s[20:23], s14 offen offset:704
    s_add_u32 s14, s14, 2688
    v_mul_u32_u24 v5, 40, v15
    v_lshl_add_u32 v5, v16, 3, v5
    s_and_b32 s16, s11, 7
    s_mul_i32 s16, s16, 1296
    s_add_u32 s16, s16, 24832
    v_add_u32 v5, s16, v5
    v_and_b32 v152, 7, v0
    v_lshrrev_b32 v153, 3, v0
    v_mul_u32_u24 v6, 1296, v152
    v_lshl_add_u32 v6, v153, 4, v6
    v_add_u32 v6, 24832, v6
    v_lshlrev_b32 v7, 8, v153
    v_lshl_add_u32 v7, v152, 4, v7
    v_mov_b32 v152, 0
    v_mov_b32 v153, 24576
    ds_write_b32 v153, v152
    s_mov_b32 s30, -1
    s_mov_b32 s31, 0
    s_mov_b32 s29, 0xffff0000
    s_mul_i32 s27, s6, 6144
    s_xor_b32 s28, s6, 2
    s_mul_i32 s28, s28, 6144
    v_mov_b32 v152, 0x3f803f80
    v_mov_b32 v153, 0x00003f80
    v_cndmask_b32 v62, 0, v152, s[30:31]
    v_cndmask_b32 v63, 0, v153, s[30:31]
    v_cndmask_b32 v70, 0, v152, s[30:31]
    v_cndmask_b32 v71, 0, v153, s[30:31]
    v_cndmask_b32 v78, 0, v152, s[30:31]
    v_cndmask_b32 v79, 0, v153, s[30:31]
    v_cndmask_b32 v86, 0, v152, s[30:31]
    v_cndmask_b32 v87, 0, v153, s[30:31]
    v_mov_b64 v[118:119], 0
    s_waitcnt vmcnt(12)
    v_cndmask_b32 v28, 0, v28, s[30:31]
    v_cndmask_b32 v29, 0, v29, s[30:31]
    v_mov_b64 v[30:31], 0
    v_cndmask_b32 v36, 0, v36, s[30:31]
    v_cndmask_b32 v37, 0, v37, s[30:31]
    v_mov_b64 v[38:39], 0
    v_cndmask_b32 v44, 0, v44, s[30:31]
    v_cndmask_b32 v45, 0, v45, s[30:31]
    v_mov_b64 v[46:47], 0
    v_cndmask_b32 v52, 0, v52, s[30:31]
    v_cndmask_b32 v53, 0, v53, s[30:31]
    v_mov_b64 v[54:55], 0
    v_mfma_f32_32x32x16_bf16 v[120:135], v[80:83], v[24:27], 0
    v_mfma_f32_32x32x16_bf16 v[136:151], v[112:115], v[24:27], 0
    v_mfma_f32_32x32x16_bf16 v[120:135], v[84:87], v[28:31], v[120:135]
    v_mfma_f32_32x32x16_bf16 v[136:151], v[116:119], v[28:31], v[136:151]
    v_mfma_f32_32x32x16_bf16 v[168:183], v[80:83], v[32:35], 0
    v_mfma_f32_32x32x16_bf16 v[184:199], v[112:115], v[32:35], 0
    v_mfma_f32_32x32x16_bf16 v[168:183], v[84:87], v[36:39], v[168:183]
    v_mfma_f32_32x32x16_bf16 v[184:199], v[116:119], v[36:39], v[184:199]
    v_mfma_f32_32x32x16_bf16 v[200:215], v[80:83], v[40:43], 0
    v_mfma_f32_32x32x16_bf16 v[216:231], v[112:115], v[40:43], 0
    v_mfma_f32_32x32x16_bf16 v[200:215], v[84:87], v[44:47], v[200:215]
    v_mfma_f32_32x32x16_bf16 v[216:231], v[116:119], v[44:47], v[216:231]
    s_nop 2
    v_max3_f32 v20, v120, v121, v122
    v_max3_f32 v20, v20, v123, v124
    v_max3_f32 v20, v20, v125, v126
    v_max3_f32 v20, v20, v127, v128
    v_max3_f32 v20, v20, v129, v130
    v_max3_f32 v20, v20, v131, v132
    v_max3_f32 v20, v20, v133, v134
    v_max3_f32 v20, v20, v135, v136
    v_max3_f32 v20, v20, v137, v138
    v_max3_f32 v20, v20, v139, v140
    v_max3_f32 v20, v20, v141, v142
    v_max3_f32 v20, v20, v143, v144
    v_max3_f32 v20, v20, v145, v146
    v_max3_f32 v20, v20, v147, v148
    v_max3_f32 v20, v20, v149, v150
    v_max_f32 v20, v20, v151
    v_mfma_f32_32x32x16_bf16 v[120:135], v[80:83], v[48:51], 0
    v_mfma_f32_32x32x16_bf16 v[136:151], v[112:115], v[48:51], 0
    v_mfma_f32_32x32x16_bf16 v[120:135], v[84:87], v[52:55], v[120:135]
    v_mfma_f32_32x32x16_bf16 v[136:151], v[116:119], v[52:55], v[136:151]
    v_max3_f32 v21, v168, v169, v170
    v_max3_f32 v21, v21, v171, v172
    v_max3_f32 v21, v21, v173, v174
    v_max3_f32 v21, v21, v175, v176
    v_max3_f32 v21, v21, v177, v178
    v_max3_f32 v21, v21, v179, v180
    v_max3_f32 v21, v21, v181, v182
    v_max3_f32 v21, v21, v183, v184
    v_max3_f32 v21, v21, v185, v186
    v_max3_f32 v21, v21, v187, v188
    v_max3_f32 v21, v21, v189, v190
    v_max3_f32 v21, v21, v191, v192
    v_max3_f32 v21, v21, v193, v194
    v_max3_f32 v21, v21, v195, v196
    v_max3_f32 v21, v21, v197, v198
    v_max_f32 v21, v21, v199
    v_max3_f32 v22, v200, v201, v202
    v_max3_f32 v22, v22, v203, v204
    v_max3_f32 v22, v22, v205, v206
    v_max3_f32 v22, v22, v207, v208
    v_max3_f32 v22, v22, v209, v210
    v_max3_f32 v22, v22, v211, v212
    v_max3_f32 v22, v22, v213, v214
    v_max3_f32 v22, v22, v215, v216
    v_max3_f32 v22, v22, v217, v218
    v_max3_f32 v22, v22, v219, v220
    v_max3_f32 v22, v22, v221, v222
    v_max3_f32 v22, v22, v223, v224
    v_max3_f32 v22, v22, v225, v226
    v_max3_f32 v22, v22, v227, v228
    v_max3_f32 v22, v22, v229, v230
    v_max_f32 v22, v22, v231
    v_max3_f32 v23, v120, v121, v122
    v_max3_f32 v23, v23, v123, v124
    v_max3_f32 v23, v23, v125, v126
    v_max3_f32 v23, v23, v127, v128
    v_max3_f32 v23, v23, v129, v130
    v_max3_f32 v23, v23, v131, v132
    v_max3_f32 v23, v23, v133, v134
    v_max3_f32 v23, v23, v135, v136
    v_max3_f32 v23, v23, v137, v138
    v_max3_f32 v23, v23, v139, v140
    v_max3_f32 v23, v23, v141, v142
    v_max3_f32 v23, v23, v143, v144
    v_max3_f32 v23, v23, v145, v146
    v_max3_f32 v23, v23, v147, v148
    v_max3_f32 v23, v23, v149, v150
    v_max_f32 v23, v23, v151
    v_mov_b32 v152, v20
    v_mov_b32 v153, v21
    v_mov_b32 v154, v22
    v_mov_b32 v155, v23
    v_permlane32_swap_b32 v20, v152
    v_permlane32_swap_b32 v21, v153
    v_permlane32_swap_b32 v22, v154
    v_permlane32_swap_b32 v23, v155
    v_max_f32 v20, v20, v152
    v_max_f32 v21, v21, v153
    v_max_f32 v22, v22, v154
    v_max_f32 v23, v23, v155
    v_add_f32 v20, 0x42c00000, v20
    v_add_f32 v21, 0x42c00000, v21
    v_add_f32 v22, 0x42c00000, v22
    v_add_f32 v23, 0x42c00000, v23
at_setslots:
    v_mov_b64 v[168:169], 0
    v_mov_b64 v[170:171], 0
    v_mov_b64 v[172:173], 0
    v_mov_b64 v[174:175], 0
    v_mov_b64 v[176:177], 0
    v_mov_b64 v[178:179], 0
    v_mov_b64 v[180:181], 0
    v_mov_b64 v[182:183], 0
    v_mov_b64 v[184:185], 0
    v_mov_b64 v[186:187], 0
    v_mov_b64 v[188:189], 0
    v_mov_b64 v[190:191], 0
    v_mov_b64 v[192:193], 0
    v_mov_b64 v[194:195], 0
    v_mov_b64 v[196:197], 0
    v_mov_b64 v[198:199], 0
    v_mov_b64 v[200:201], 0
    v_mov_b64 v[202:203], 0
    v_mov_b64 v[204:205], 0
    v_mov_b64 v[206:207], 0
    v_mov_b64 v[208:209], 0
    v_mov_b64 v[210:211], 0
    v_mov_b64 v[212:213], 0
    v_mov_b64 v[214:215], 0
    v_mov_b64 v[216:217], 0
    v_mov_b64 v[218:219], 0
    v_mov_b64 v[220:221], 0
    v_mov_b64 v[222:223], 0
    v_mov_b64 v[224:225], 0
    v_mov_b64 v[226:227], 0
    v_mov_b64 v[228:229], 0
    v_mov_b64 v[230:231], 0
    v_mov_b64 v[164:165], 0
    v_mov_b64 v[166:167], 0
    v_mov_b64 v[116:117], 0
    v_mov_b64 v[118:119], 0
    v_sub_f32 v152, 0, v20
    v_and_b32 v153, s29, v152
    v_sub_f32 v152, v152, v153
    v_and_b32 v154, s29, v152
    v_sub_f32 v152, v152, v154
    v_lshrrev_b32 v153, 16, v153
    v_or_b32 v153, v153, v154
    v_lshrrev_b32 v152, 16, v152
    v_cndmask_b32 v30, 0, v153, s[30:31]
    v_cndmask_b32 v31, 0, v152, s[30:31]
    s_waitcnt vmcnt(8)
    v_mfma_f32_32x32x16_bf16 v[120:135], v[56:59], v[24:27], 0
    v_mfma_f32_32x32x16_bf16 v[120:135], v[60:63], v[28:31], v[120:135]
    v_sub_f32 v152, 0, v21
    v_and_b32 v153, s29, v152
    v_sub_f32 v152, v152, v153
    v_and_b32 v154, s29, v152
    v_sub_f32 v152, v152, v154
    v_lshrrev_b32 v153, 16, v153
    v_or_b32 v153, v153, v154
    v_lshrrev_b32 v152, 16, v152
    v_cndmask_b32 v38, 0, v153, s[30:31]
    v_cndmask_b32 v39, 0, v152, s[30:31]
    v_sub_f32 v152, 0, v22
    v_and_b32 v153, s29, v152
    v_sub_f32 v152, v152, v153
    v_and_b32 v154, s29, v152
    v_sub_f32 v152, v152, v154
    v_lshrrev_b32 v153, 16, v153
    v_or_b32 v153, v153, v154
    v_lshrrev_b32 v152, 16, v152
    v_cndmask_b32 v46, 0, v153, s[30:31]
    v_cndmask_b32 v47, 0, v152, s[30:31]
    v_sub_f32 v152, 0, v23
    v_and_b32 v153, s29, v152
    v_sub_f32 v152, v152, v153
    v_and_b32 v154, s29, v152
    v_sub_f32 v152, v152, v154
    v_lshrrev_b32 v153, 16, v153
    v_or_b32 v153, v153, v154
    v_lshrrev_b32 v152, 16, v152
    v_cndmask_b32 v54, 0, v153, s[30:31]
    v_cndmask_b32 v55, 0, v152, s[30:31]
    s_mov_b32 s12, 8
.p2align 6
at_loop:
    v_mfma_f32_32x32x16_bf16 v[136:151], v[56:59], v[32:35], 0
    v_exp_f32 v120, v120
    v_exp_f32 v121, v121
    v_exp_f32 v122, v122
    v_exp_f32 v123, v123
    v_cvt_pk_bf16_f32 v152, v120, v121
    v_cvt_pk_bf16_f32 v153, v122, v123
    v_mfma_f32_32x32x16_bf16 v[136:151], v[60:63], v[36:39], v[136:151]
    v_exp_f32 v124, v124
    v_exp_f32 v125, v125
    v_exp_f32 v126, v126
    v_exp_f32 v127, v127
    v_cvt_pk_bf16_f32 v154, v124, v125
    v_cvt_pk_bf16_f32 v155, v126, v127
    v_mfma_f32_32x32x16_bf16 v[216:231], v[116:119], v[164:167], v[216:231]
    buffer_load_dwordx4 v[80:83], v2, s[20:23], s14 offen
    buffer_load_dwordx2 v[84:85], v9, s[20:23], s14 offen
    buffer_load_dwordx4 v[112:115], v10, s[20:23], s14 offen
    buffer_load_dwordx4 v[116:119], v10, s[20:23], s14 offen offset:704
    s_add_u32 s14, s14, 13440
    v_exp_f32 v128, v128
    v_exp_f32 v129, v129
    v_exp_f32 v130, v130
    v_exp_f32 v131, v131
    v_cvt_pk_bf16_f32 v156, v128, v129
    v_cvt_pk_bf16_f32 v157, v130, v131
    v_mfma_f32_32x32x16_bf16 v[168:183], v[88:91], v[152:155], v[168:183]
    v_exp_f32 v132, v132
    v_exp_f32 v133, v133
    v_exp_f32 v134, v134
    v_exp_f32 v135, v135
    v_cvt_pk_bf16_f32 v158, v132, v133
    v_cvt_pk_bf16_f32 v159, v134, v135
    v_mfma_f32_32x32x16_bf16 v[120:135], v[56:59], v[40:43], 0
    v_exp_f32 v136, v136
    v_exp_f32 v137, v137
    v_exp_f32 v138, v138
    v_exp_f32 v139, v139
    v_cvt_pk_bf16_f32 v160, v136, v137
    v_cvt_pk_bf16_f32 v161, v138, v139
    v_mfma_f32_32x32x16_bf16 v[120:135], v[60:63], v[44:47], v[120:135]
    v_exp_f32 v140, v140
    v_exp_f32 v141, v141
    v_exp_f32 v142, v142
    v_exp_f32 v143, v143
    v_cvt_pk_bf16_f32 v162, v140, v141
    v_cvt_pk_bf16_f32 v163, v142, v143
    v_mfma_f32_32x32x16_bf16 v[168:183], v[92:95], v[156:159], v[168:183]
    v_exp_f32 v144, v144
    v_exp_f32 v145, v145
    v_exp_f32 v146, v146
    v_exp_f32 v147, v147
    v_cvt_pk_bf16_f32 v164, v144, v145
    v_cvt_pk_bf16_f32 v165, v146, v147
    v_mfma_f32_32x32x16_bf16 v[184:199], v[88:91], v[160:163], v[184:199]
    v_exp_f32 v148, v148
    v_exp_f32 v149, v149
    v_exp_f32 v150, v150
    v_exp_f32 v151, v151
    v_cvt_pk_bf16_f32 v166, v148, v149
    v_cvt_pk_bf16_f32 v167, v150, v151
    v_mfma_f32_32x32x16_bf16 v[136:151], v[56:59], v[48:51], 0
    v_exp_f32 v120, v120
    v_exp_f32 v121, v121
    v_exp_f32 v122, v122
    v_exp_f32 v123, v123
    v_cvt_pk_bf16_f32 v152, v120, v121
    v_cvt_pk_bf16_f32 v153, v122, v123
    v_mfma_f32_32x32x16_bf16 v[136:151], v[60:63], v[52:55], v[136:151]
    v_exp_f32 v124, v124
    v_exp_f32 v125, v125
    v_exp_f32 v126, v126
    v_exp_f32 v127, v127
    v_cvt_pk_bf16_f32 v154, v124, v125
    v_cvt_pk_bf16_f32 v155, v126, v127
    v_mfma_f32_32x32x16_bf16 v[184:199], v[92:95], v[164:167], v[184:199]
    v_exp_f32 v128, v128
    v_exp_f32 v129, v129
    v_exp_f32 v130, v130
    v_exp_f32 v131, v131
    v_cvt_pk_bf16_f32 v156, v128, v129
    v_cvt_pk_bf16_f32 v157, v130, v131
    v_mfma_f32_32x32x16_bf16 v[200:215], v[88:91], v[152:155], v[200:215]
    v_exp_f32 v132, v132
    v_exp_f32 v133, v133
    v_exp_f32 v134, v134
    v_exp_f32 v135, v135
    v_cvt_pk_bf16_f32 v158, v132, v133
    v_cvt_pk_bf16_f32 v159, v134, v135
    s_waitcnt vmcnt(8)
    v_mfma_f32_32x32x16_bf16 v[120:135], v[64:67], v[24:27], 0
    v_exp_f32 v136, v136
    v_exp_f32 v137, v137
    v_exp_f32 v138, v138
    v_exp_f32 v139, v139
    v_cvt_pk_bf16_f32 v160, v136, v137
    v_cvt_pk_bf16_f32 v161, v138, v139
    v_mfma_f32_32x32x16_bf16 v[120:135], v[68:71], v[28:31], v[120:135]
    v_exp_f32 v140, v140
    v_exp_f32 v141, v141
    v_exp_f32 v142, v142
    v_exp_f32 v143, v143
    v_cvt_pk_bf16_f32 v162, v140, v141
    v_cvt_pk_bf16_f32 v163, v142, v143
    v_mfma_f32_32x32x16_bf16 v[200:215], v[92:95], v[156:159], v[200:215]
    v_exp_f32 v144, v144
    v_exp_f32 v145, v145
    v_exp_f32 v146, v146
    v_exp_f32 v147, v147
    v_cvt_pk_bf16_f32 v164, v144, v145
    v_cvt_pk_bf16_f32 v165, v146, v147
    v_mfma_f32_32x32x16_bf16 v[216:231], v[88:91], v[160:163], v[216:231]
    v_exp_f32 v148, v148
    v_exp_f32 v149, v149
    v_exp_f32 v150, v150
    v_exp_f32 v151, v151
    v_cvt_pk_bf16_f32 v166, v148, v149
    v_cvt_pk_bf16_f32 v167, v150, v151
    v_mfma_f32_32x32x16_bf16 v[136:151], v[64:67], v[32:35], 0
    v_exp_f32 v120, v120
    v_exp_f32 v121, v121
    v_exp_f32 v122, v122
    v_exp_f32 v123, v123
    v_cvt_pk_bf16_f32 v152, v120, v121
    v_cvt_pk_bf16_f32 v153, v122, v123
    v_mfma_f32_32x32x16_bf16 v[136:151], v[68:71], v[36:39], v[136:151]
    v_exp_f32 v124, v124
    v_exp_f32 v125, v125
    v_exp_f32 v126, v126
    v_exp_f32 v127, v127
    v_cvt_pk_bf16_f32 v154, v124, v125
    v_cvt_pk_bf16_f32 v155, v126, v127
    v_mfma_f32_32x32x16_bf16 v[216:231], v[92:95], v[164:167], v[216:231]
    buffer_load_dwordx4 v[56:59], v2, s[20:23], s14 offen
    buffer_load_dwordx2 v[60:61], v9, s[20:23], s14 offen
    buffer_load_dwordx4 v[88:91], v10, s[20:23], s14 offen
    buffer_load_dwordx4 v[92:95], v10, s[20:23], s14 offen offset:704
    s_add_u32 s14, s14, 2688
    v_exp_f32 v128, v128
    v_exp_f32 v129, v129
    v_exp_f32 v130, v130
    v_exp_f32 v131, v131
    v_cvt_pk_bf16_f32 v156, v128, v129
    v_cvt_pk_bf16_f32 v157, v130, v131
    v_mfma_f32_32x32x16_bf16 v[168:183], v[96:99], v[152:155], v[168:183]
    v_exp_f32 v132, v132
    v_exp_f32 v133, v133
    v_exp_f32 v134, v134
    v_exp_f32 v135, v135
    v_cvt_pk_bf16_f32 v158, v132, v133
    v_cvt_pk_bf16_f32 v159, v134, v135
    v_mfma_f32_32x32x16_bf16 v[120:135], v[64:67], v[40:43], 0
    v_exp_f32 v136, v136
    v_exp_f32 v137, v137
    v_exp_f32 v138, v138
    v_exp_f32 v139, v139
    v_cvt_pk_bf16_f32 v160, v136, v137
    v_cvt_pk_bf16_f32 v161, v138, v139
    v_mfma_f32_32x32x16_bf16 v[120:135], v[68:71], v[44:47], v[120:135]
    v_exp_f32 v140, v140
    v_exp_f32 v141, v141
    v_exp_f32 v142, v142
    v_exp_f32 v143, v143
    v_cvt_pk_bf16_f32 v162, v140, v141
    v_cvt_pk_bf16_f32 v163, v142, v143
    v_mfma_f32_32x32x16_bf16 v[168:183], v[100:103], v[156:159], v[168:183]
    v_exp_f32 v144, v144
    v_exp_f32 v145, v145
    v_exp_f32 v146, v146
    v_exp_f32 v147, v147
    v_cvt_pk_bf16_f32 v164, v144, v145
    v_cvt_pk_bf16_f32 v165, v146, v147
    v_mfma_f32_32x32x16_bf16 v[184:199], v[96:99], v[160:163], v[184:199]
    v_exp_f32 v148, v148
    v_exp_f32 v149, v149
    v_exp_f32 v150, v150
    v_exp_f32 v151, v151
    v_cvt_pk_bf16_f32 v166, v148, v149
    v_cvt_pk_bf16_f32 v167, v150, v151
    v_mfma_f32_32x32x16_bf16 v[136:151], v[64:67], v[48:51], 0
    v_exp_f32 v120, v120
    v_exp_f32 v121, v121
    v_exp_f32 v122, v122
    v_exp_f32 v123, v123
    v_cvt_pk_bf16_f32 v152, v120, v121
    v_cvt_pk_bf16_f32 v153, v122, v123
    v_mfma_f32_32x32x16_bf16 v[136:151], v[68:71], v[52:55], v[136:151]
    v_exp_f32 v124, v124
    v_exp_f32 v125, v125
    v_exp_f32 v126, v126
    v_exp_f32 v127, v127
    v_cvt_pk_bf16_f32 v154, v124, v125
    v_cvt_pk_bf16_f32 v155, v126, v127
    v_mfma_f32_32x32x16_bf16 v[184:199], v[100:103], v[164:167], v[184:199]
    v_exp_f32 v128, v128
    v_exp_f32 v129, v129
    v_exp_f32 v130, v130
    v_exp_f32 v131, v131
    v_cvt_pk_bf16_f32 v156, v128, v129
    v_cvt_pk_bf16_f32 v157, v130, v131
    v_mfma_f32_32x32x16_bf16 v[200:215], v[96:99], v[152:155], v[200:215]
    v_exp_f32 v132, v132
    v_exp_f32 v133, v133
    v_exp_f32 v134, v134
    v_exp_f32 v135, v135
    v_cvt_pk_bf16_f32 v158, v132, v133
    v_cvt_pk_bf16_f32 v159, v134, v135
    s_waitcnt vmcnt(8)
    v_mfma_f32_32x32x16_bf16 v[120:135], v[72:75], v[24:27], 0
    v_exp_f32 v136, v136
    v_exp_f32 v137, v137
    v_exp_f32 v138, v138
    v_exp_f32 v139, v139
    v_cvt_pk_bf16_f32 v160, v136, v137
    v_cvt_pk_bf16_f32 v161, v138, v139
    v_mfma_f32_32x32x16_bf16 v[120:135], v[76:79], v[28:31], v[120:135]
    v_exp_f32 v140, v140
    v_exp_f32 v141, v141
    v_exp_f32 v142, v142
    v_exp_f32 v143, v143
    v_cvt_pk_bf16_f32 v162, v140, v141
    v_cvt_pk_bf16_f32 v163, v142, v143
    v_mfma_f32_32x32x16_bf16 v[200:215], v[100:103], v[156:159], v[200:215]
    v_exp_f32 v144, v144
    v_exp_f32 v145, v145
    v_exp_f32 v146, v146
    v_exp_f32 v147, v147
    v_cvt_pk_bf16_f32 v164, v144, v145
    v_cvt_pk_bf16_f32 v165, v146, v147
    v_mfma_f32_32x32x16_bf16 v[216:231], v[96:99], v[160:163], v[216:231]
    v_exp_f32 v148, v148
    v_exp_f32 v149, v149
    v_exp_f32 v150, v150
    v_exp_f32 v151, v151
    v_cvt_pk_bf16_f32 v166, v148, v149
    v_cvt_pk_bf16_f32 v167, v150, v151
    v_mfma_f32_32x32x16_bf16 v[136:151], v[72:75], v[32:35], 0
    v_exp_f32 v120, v120
    v_exp_f32 v121, v121
    v_exp_f32 v122, v122
    v_exp_f32 v123, v123
    v_cvt_pk_bf16_f32 v152, v120, v121
    v_cvt_pk_bf16_f32 v153, v122, v123
    v_mfma_f32_32x32x16_bf16 v[136:151], v[76:79], v[36:39], v[136:151]
    v_exp_f32 v124, v124
    v_exp_f32 v125, v125
    v_exp_f32 v126, v126
    v_exp_f32 v127, v127
    v_cvt_pk_bf16_f32 v154, v124, v125
    v_cvt_pk_bf16_f32 v155, v126, v127
    v_mfma_f32_32x32x16_bf16 v[216:231], v[100:103], v[164:167], v[216:231]
    buffer_load_dwordx4 v[64:67], v2, s[20:23], s14 offen
    buffer_load_dwordx2 v[68:69], v9, s[20:23], s14 offen
    buffer_load_dwordx4 v[96:99], v10, s[20:23], s14 offen
    buffer_load_dwordx4 v[100:103], v10, s[20:23], s14 offen offset:704
    s_add_u32 s14, s14, 2688
    v_exp_f32 v128, v128
    v_exp_f32 v129, v129
    v_exp_f32 v130, v130
    v_exp_f32 v131, v131
    v_cvt_pk_bf16_f32 v156, v128, v129
    v_cvt_pk_bf16_f32 v157, v130, v131
    v_mfma_f32_32x32x16_bf16 v[168:183], v[104:107], v[152:155], v[168:183]
    v_exp_f32 v132, v132
    v_exp_f32 v133, v133
    v_exp_f32 v134, v134
    v_exp_f32 v135, v135
    v_cvt_pk_bf16_f32 v158, v132, v133
    v_cvt_pk_bf16_f32 v159, v134, v135
    v_mfma_f32_32x32x16_bf16 v[120:135], v[72:75], v[40:43], 0
    v_exp_f32 v136, v136
    v_exp_f32 v137, v137
    v_exp_f32 v138, v138
    v_exp_f32 v139, v139
    v_cvt_pk_bf16_f32 v160, v136, v137
    v_cvt_pk_bf16_f32 v161, v138, v139
    v_mfma_f32_32x32x16_bf16 v[120:135], v[76:79], v[44:47], v[120:135]
    v_exp_f32 v140, v140
    v_exp_f32 v141, v141
    v_exp_f32 v142, v142
    v_exp_f32 v143, v143
    v_cvt_pk_bf16_f32 v162, v140, v141
    v_cvt_pk_bf16_f32 v163, v142, v143
    v_mfma_f32_32x32x16_bf16 v[168:183], v[108:111], v[156:159], v[168:183]
    v_exp_f32 v144, v144
    v_exp_f32 v145, v145
    v_exp_f32 v146, v146
    v_exp_f32 v147, v147
    v_cvt_pk_bf16_f32 v164, v144, v145
    v_cvt_pk_bf16_f32 v165, v146, v147
    v_mfma_f32_32x32x16_bf16 v[184:199], v[104:107], v[160:163], v[184:199]
    v_exp_f32 v148, v148
    v_exp_f32 v149, v149
    v_exp_f32 v150, v150
    v_exp_f32 v151, v151
    v_cvt_pk_bf16_f32 v166, v148, v149
    v_cvt_pk_bf16_f32 v167, v150, v151
    v_mfma_f32_32x32x16_bf16 v[136:151], v[72:75], v[48:51], 0
    v_exp_f32 v120, v120
    v_exp_f32 v121, v121
    v_exp_f32 v122, v122
    v_exp_f32 v123, v123
    v_cvt_pk_bf16_f32 v152, v120, v121
    v_cvt_pk_bf16_f32 v153, v122, v123
    v_mfma_f32_32x32x16_bf16 v[136:151], v[76:79], v[52:55], v[136:151]
    v_exp_f32 v124, v124
    v_exp_f32 v125, v125
    v_exp_f32 v126, v126
    v_exp_f32 v127, v127
    v_cvt_pk_bf16_f32 v154, v124, v125
    v_cvt_pk_bf16_f32 v155, v126, v127
    v_mfma_f32_32x32x16_bf16 v[184:199], v[108:111], v[164:167], v[184:199]
    v_exp_f32 v128, v128
    v_exp_f32 v129, v129
    v_exp_f32 v130, v130
    v_exp_f32 v131, v131
    v_cvt_pk_bf16_f32 v156, v128, v129
    v_cvt_pk_bf16_f32 v157, v130, v131
    v_mfma_f32_32x32x16_bf16 v[200:215], v[104:107], v[152:155], v[200:215]
    v_exp_f32 v132, v132
    v_exp_f32 v133, v133
    v_exp_f32 v134, v134
    v_exp_f32 v135, v135
    v_cvt_pk_bf16_f32 v158, v132, v133
    v_cvt_pk_bf16_f32 v159, v134, v135
    s_waitcnt vmcnt(8)
    v_mfma_f32_32x32x16_bf16 v[120:135], v[80:83], v[24:27], 0
    v_exp_f32 v136, v136
    v_exp_f32 v137, v137
    v_exp_f32 v138, v138
    v_exp_f32 v139, v139
    v_cvt_pk_bf16_f32 v160, v136, v137
    v_cvt_pk_bf16_f32 v161, v138, v139
    v_mfma_f32_32x32x16_bf16 v[120:135], v[84:87], v[28:31], v[120:135]
    v_exp_f32 v140, v140
    v_exp_f32 v141, v141
    v_exp_f32 v142, v142
    v_exp_f32 v143, v143
    v_cvt_pk_bf16_f32 v162, v140, v141
    v_cvt_pk_bf16_f32 v163, v142, v143
    v_mfma_f32_32x32x16_bf16 v[200:215], v[108:111], v[156:159], v[200:215]
    v_exp_f32 v144, v144
    v_exp_f32 v145, v145
    v_exp_f32 v146, v146
    v_exp_f32 v147, v147
    v_cvt_pk_bf16_f32 v164, v144, v145
    v_cvt_pk_bf16_f32 v165, v146, v147
    v_mfma_f32_32x32x16_bf16 v[216:231], v[104:107], v[160:163], v[216:231]
    v_exp_f32 v148, v148
    v_exp_f32 v149, v149
    v_exp_f32 v150, v150
    v_exp_f32 v151, v151
    v_cvt_pk_bf16_f32 v166, v148, v149
    v_cvt_pk_bf16_f32 v167, v150, v151
    v_mfma_f32_32x32x16_bf16 v[136:151], v[80:83], v[32:35], 0
    v_exp_f32 v120, v120
    v_exp_f32 v121, v121
    v_exp_f32 v122, v122
    v_exp_f32 v123, v123
    v_cvt_pk_bf16_f32 v152, v120, v121
    v_cvt_pk_bf16_f32 v153, v122, v123
    v_mfma_f32_32x32x16_bf16 v[136:151], v[84:87], v[36:39], v[136:151]
    v_exp_f32 v124, v124
    v_exp_f32 v125, v125
    v_exp_f32 v126, v126
    v_exp_f32 v127, v127
    v_cvt_pk_bf16_f32 v154, v124, v125
    v_cvt_pk_bf16_f32 v155, v126, v127
    v_mfma_f32_32x32x16_bf16 v[216:231], v[108:111], v[164:167], v[216:231]
    buffer_load_dwordx4 v[72:75], v2, s[20:23], s14 offen
    buffer_load_dwordx2 v[76:77], v9, s[20:23], s14 offen
    buffer_load_dwordx4 v[104:107], v10, s[20:23], s14 offen
    buffer_load_dwordx4 v[108:111], v10, s[20:23], s14 offen offset:704
    s_add_u32 s14, s14, 2688
    v_exp_f32 v128, v128
    v_exp_f32 v129, v129
    v_exp_f32 v130, v130
    v_exp_f32 v131, v131
    v_cvt_pk_bf16_f32 v156, v128, v129
    v_cvt_pk_bf16_f32 v157, v130, v131
    v_mfma_f32_32x32x16_bf16 v[168:183], v[112:115], v[152:155], v[168:183]
    v_exp_f32 v132, v132
    v_exp_f32 v133, v133
    v_exp_f32 v134, v134
    v_exp_f32 v135, v135
    v_cvt_pk_bf16_f32 v158, v132, v133
    v_cvt_pk_bf16_f32 v159, v134, v135
    v_mfma_f32_32x32x16_bf16 v[120:135], v[80:83], v[40:43], 0
    v_exp_f32 v136, v136
    v_exp_f32 v137, v137
    v_exp_f32 v138, v138
    v_exp_f32 v139, v139
    v_cvt_pk_bf16_f32 v160, v136, v137
    v_cvt_pk_bf16_f32 v161, v138, v139
    v_mfma_f32_32x32x16_bf16 v[120:135], v[84:87], v[44:47], v[120:135]
    v_exp_f32 v140, v140
    v_exp_f32 v141, v141
    v_exp_f32 v142, v142
    v_exp_f32 v143, v143
    v_cvt_pk_bf16_f32 v162, v140, v141
    v_cvt_pk_bf16_f32 v163, v142, v143
    v_mfma_f32_32x32x16_bf16 v[168:183], v[116:119], v[156:159], v[168:183]
    v_exp_f32 v144, v144
    v_exp_f32 v145, v145
    v_exp_f32 v146, v146
    v_exp_f32 v147, v147
    v_cvt_pk_bf16_f32 v164, v144, v145
    v_cvt_pk_bf16_f32 v165, v146, v147
    v_mfma_f32_32x32x16_bf16 v[184:199], v[112:115], v[160:163], v[184:199]
    v_exp_f32 v148, v148
    v_exp_f32 v149, v149
    v_exp_f32 v150, v150
    v_exp_f32 v151, v151
    v_cvt_pk_bf16_f32 v166, v148, v149
    v_cvt_pk_bf16_f32 v167, v150, v151
    v_mfma_f32_32x32x16_bf16 v[136:151], v[80:83], v[48:51], 0
    v_exp_f32 v120, v120
    v_exp_f32 v121, v121
    v_exp_f32 v122, v122
    v_exp_f32 v123, v123
    v_cvt_pk_bf16_f32 v152, v120, v121
    v_cvt_pk_bf16_f32 v153, v122, v123
    v_mfma_f32_32x32x16_bf16 v[136:151], v[84:87], v[52:55], v[136:151]
    v_exp_f32 v124, v124
    v_exp_f32 v125, v125
    v_exp_f32 v126, v126
    v_exp_f32 v127, v127
    v_cvt_pk_bf16_f32 v154, v124, v125
    v_cvt_pk_bf16_f32 v155, v126, v127
    v_mfma_f32_32x32x16_bf16 v[184:199], v[116:119], v[164:167], v[184:199]
    v_exp_f32 v128, v128
    v_exp_f32 v129, v129
    v_exp_f32 v130, v130
    v_exp_f32 v131, v131
    v_cvt_pk_bf16_f32 v156, v128, v129
    v_cvt_pk_bf16_f32 v157, v130, v131
    v_mfma_f32_32x32x16_bf16 v[200:215], v[112:115], v[152:155], v[200:215]
    v_exp_f32 v132, v132
    v_exp_f32 v133, v133
    v_exp_f32 v134, v134
    v_exp_f32 v135, v135
    v_cvt_pk_bf16_f32 v158, v132, v133
    v_cvt_pk_bf16_f32 v159, v134, v135
    s_waitcnt vmcnt(8)
    v_mfma_f32_32x32x16_bf16 v[120:135], v[56:59], v[24:27], 0
    v_exp_f32 v136, v136
    v_exp_f32 v137, v137
    v_exp_f32 v138, v138
    v_exp_f32 v139, v139
    v_cvt_pk_bf16_f32 v160, v136, v137
    v_cvt_pk_bf16_f32 v161, v138, v139
    v_mfma_f32_32x32x16_bf16 v[120:135], v[60:63], v[28:31], v[120:135]
    v_exp_f32 v140, v140
    v_exp_f32 v141, v141
    v_exp_f32 v142, v142
    v_exp_f32 v143, v143
    v_cvt_pk_bf16_f32 v162, v140, v141
    v_cvt_pk_bf16_f32 v163, v142, v143
    v_mfma_f32_32x32x16_bf16 v[200:215], v[116:119], v[156:159], v[200:215]
    v_exp_f32 v144, v144
    v_exp_f32 v145, v145
    v_exp_f32 v146, v146
    v_exp_f32 v147, v147
    v_cvt_pk_bf16_f32 v164, v144, v145
    v_cvt_pk_bf16_f32 v165, v146, v147
    v_mfma_f32_32x32x16_bf16 v[216:231], v[112:115], v[160:163], v[216:231]
    s_sub_u32 s12, s12, 1
    s_cmp_lg_u32 s12, 0
    v_exp_f32 v148, v148
    v_exp_f32 v149, v149
    v_exp_f32 v150, v150
    v_exp_f32 v151, v151
    v_cvt_pk_bf16_f32 v166, v148, v149
    v_cvt_pk_bf16_f32 v167, v150, v151
    s_cbranch_scc1 at_loop
    s_nop 0
    v_mfma_f32_32x32x16_bf16 v[216:231], v[116:119], v[164:167], v[216:231]
    v_add_u32 v17, s27, v2
    s_lshr_b32 s16, s3, 1
    s_mul_i32 s16, s16, 75776
    s_and_b32 s18, s3, 1
    s_lshl_b32 s18, s18, 7
    s_add_u32 s16, s16, s18
    s_add_u32 s18, s16, 8388608
    ds_write_b128 v17, v[200:203] offset:0
    ds_write_b128 v17, v[204:207] offset:1024
    ds_write_b128 v17, v[208:211] offset:2048
    s_nop 1
    ds_write_b128 v17, v[216:219] offset:3072
    ds_write_b128 v17, v[220:223] offset:4096
    ds_write_b128 v17, v[224:227] offset:5120
    v_add_u32 v17, s28, v2
    s_waitcnt lgkmcnt(0)
    s_barrier
    ds_read_b128 v[120:123], v17 offset:0
    ds_read_b128 v[124:127], v17 offset:1024
    ds_read_b128 v[128:131], v17 offset:2048
    ds_read_b128 v[136:139], v17 offset:3072
    ds_read_b128 v[140:143], v17 offset:4096
    ds_read_b128 v[144:147], v17 offset:5120
    s_waitcnt lgkmcnt(3)
    v_pk_add_f32 v[168:169], v[168:169], v[120:121]
    v_pk_add_f32 v[170:171], v[170:171], v[122:123]
    v_pk_add_f32 v[172:173], v[172:173], v[124:125]
    v_pk_add_f32 v[174:175], v[174:175], v[126:127]
    v_pk_add_f32 v[176:177], v[176:177], v[128:129]
    v_pk_add_f32 v[178:179], v[178:179], v[130:131]
    v_mov_b32 v120, v176
    v_mov_b32 v121, v176
    s_nop 1
    v_permlane32_swap_b32 v120, v121
    v_rcp_f32 v122, v121
    v_mul_f32 v120, 0x43800000, v121
    v_pk_mul_f32 v[168:169], v[168:169], v[122:123] op_sel_hi:[1,0]
    v_pk_mul_f32 v[170:171], v[170:171], v[122:123] op_sel_hi:[1,0]
    v_pk_mul_f32 v[172:173], v[172:173], v[122:123] op_sel_hi:[1,0]
    v_pk_mul_f32 v[174:175], v[174:175], v[122:123] op_sel_hi:[1,0]
    v_pk_mul_f32 v[176:177], v[176:177], v[122:123] op_sel_hi:[1,0]
    v_pk_mul_f32 v[178:179], v[178:179], v[122:123] op_sel_hi:[1,0]
    v_cvt_pk_bf16_f32 v200, v168, v169
    v_cvt_pk_bf16_f32 v201, v170, v171
    v_cvt_pk_bf16_f32 v202, v172, v173
    v_cvt_pk_bf16_f32 v203, v174, v175
    v_cvt_pk_bf16_f32 v204, v176, v177
    v_cvt_pk_bf16_f32 v205, v178, v179
    ds_write_b64 v5, v[200:201] offset:0
    ds_write_b64 v5, v[202:203] offset:16
    v_pk_add_f32 v[168:169], v[168:169], v[170:171]
    v_pk_add_f32 v[168:169], v[168:169], v[172:173]
    v_pk_add_f32 v[168:169], v[168:169], v[174:175]
    v_pk_add_f32 v[168:169], v[168:169], v[176:177]
    v_pk_add_f32 v[168:169], v[168:169], v[178:179]
    v_add_f32 v14, v120, v168
    v_add_f32 v14, v14, v169
    s_waitcnt lgkmcnt(0)
    v_pk_add_f32 v[184:185], v[184:185], v[136:137]
    v_pk_add_f32 v[186:187], v[186:187], v[138:139]
    v_pk_add_f32 v[188:189], v[188:189], v[140:141]
    v_pk_add_f32 v[190:191], v[190:191], v[142:143]
    v_pk_add_f32 v[192:193], v[192:193], v[144:145]
    v_pk_add_f32 v[194:195], v[194:195], v[146:147]
    v_mov_b32 v136, v192
    v_mov_b32 v137, v192
    s_nop 1
    v_permlane32_swap_b32 v136, v137
    v_rcp_f32 v138, v137
    v_mul_f32 v136, 0x43800000, v137
    v_pk_mul_f32 v[184:185], v[184:185], v[138:139] op_sel_hi:[1,0]
    v_pk_mul_f32 v[186:187], v[186:187], v[138:139] op_sel_hi:[1,0]
    v_pk_mul_f32 v[188:189], v[188:189], v[138:139] op_sel_hi:[1,0]
    v_pk_mul_f32 v[190:191], v[190:191], v[138:139] op_sel_hi:[1,0]
    v_pk_mul_f32 v[192:193], v[192:193], v[138:139] op_sel_hi:[1,0]
    v_pk_mul_f32 v[194:195], v[194:195], v[138:139] op_sel_hi:[1,0]
    v_cvt_pk_bf16_f32 v208, v184, v185
    v_cvt_pk_bf16_f32 v209, v186, v187
    v_cvt_pk_bf16_f32 v210, v188, v189
    v_cvt_pk_bf16_f32 v211, v190, v191
    v_cvt_pk_bf16_f32 v212, v192, v193
    v_cvt_pk_bf16_f32 v213, v194, v195
    ds_write_b64 v5, v[208:209] offset:1296
    ds_write_b64 v5, v[210:211] offset:1312
    v_pk_add_f32 v[184:185], v[184:185], v[186:187]
    v_pk_add_f32 v[184:185], v[184:185], v[188:189]
    v_pk_add_f32 v[184:185], v[184:185], v[190:191]
    v_pk_add_f32 v[184:185], v[184:185], v[192:193]
    v_pk_add_f32 v[184:185], v[184:185], v[194:195]
    v_add_f32 v14, v14, v136
    v_add_f32 v14, v14, v184
    v_add_f32 v14, v14, v185
    s_mov_b64 exec, s[30:31]
    ds_write_b64 v5, v[204:205] offset:32
    ds_write_b64 v5, v[212:213] offset:1328
    s_mov_b64 exec, -1
    v_mov_b32 v152, 0x207
    v_cmp_class_f32 vcc, v14, v152
    v_mov_b32 v153, 24576
    v_mov_b32 v154, 1
    s_cmp_eq_u64 vcc, 0
    s_cbranch_scc1 at_noflag
    ds_write_b32 v153, v154
at_noflag:
    s_waitcnt lgkmcnt(0)
    s_barrier
    ds_read_b32 v154, v153
    ds_read_b128 v[120:123], v6
    ds_read_b128 v[124:127], v6 offset:512
    ds_read_b128 v[128:131], v6 offset:1024
    s_waitcnt lgkmcnt(0)
    v_readfirstlane_b32 s16, v154
    s_cmp_lg_u32 s26, 0
    s_cbranch_scc1 at_store
    s_cmp_eq_u32 s16, 0
    s_cbranch_scc1 at_store
    s_mov_b32 s26, 1
    v_mov_b64 v[30:31], 0
    v_mov_b32 v20, 0xff800000
    v_mov_b64 v[38:39], 0
    v_mov_b32 v21, 0xff800000
    v_mov_b64 v[46:47], 0
    v_mov_b32 v22, 0xff800000
    v_mov_b64 v[54:55], 0
    v_mov_b32 v23, 0xff800000
    s_mov_b32 s14, 6291456
    s_mov_b32 s12, 64
    s_waitcnt vmcnt(0)
at_fbloop:
    buffer_load_dwordx4 v[56:59], v2, s[20:23], s14 offen
    buffer_load_dwordx2 v[60:61], v9, s[20:23], s14 offen
    s_add_u32 s14, s14, 2688
    s_waitcnt vmcnt(0)
    v_mfma_f32_32x32x16_bf16 v[168:183], v[56:59], v[24:27], 0
    v_mfma_f32_32x32x16_bf16 v[168:183], v[60:63], v[28:31], v[168:183]
    v_mfma_f32_32x32x16_bf16 v[184:199], v[56:59], v[32:35], 0
    v_mfma_f32_32x32x16_bf16 v[184:199], v[60:63], v[36:39], v[184:199]
    v_mfma_f32_32x32x16_bf16 v[200:215], v[56:59], v[40:43], 0
    v_mfma_f32_32x32x16_bf16 v[200:215], v[60:63], v[44:47], v[200:215]
    v_mfma_f32_32x32x16_bf16 v[216:231], v[56:59], v[48:51], 0
    v_mfma_f32_32x32x16_bf16 v[216:231], v[60:63], v[52:55], v[216:231]
    s_nop 5
    v_max3_f32 v20, v20, v168, v169
    v_max3_f32 v20, v20, v170, v171
    v_max3_f32 v20, v20, v172, v173
    v_max3_f32 v20, v20, v174, v175
    v_max3_f32 v20, v20, v176, v177
    v_max3_f32 v20, v20, v178, v179
    v_max3_f32 v20, v20, v180, v181
    v_max3_f32 v20, v20, v182, v183
    v_max3_f32 v21, v21, v184, v185
    v_max3_f32 v21, v21, v186, v187
    v_max3_f32 v21, v21, v188, v189
    v_max3_f32 v21, v21, v190, v191
    v_max3_f32 v21, v21, v192, v193
    v_max3_f32 v21, v21, v194, v195
    v_max3_f32 v21, v21, v196, v197
    v_max3_f32 v21, v21, v198, v199
    v_max3_f32 v22, v22, v200, v201
    v_max3_f32 v22, v22, v202, v203
    v_max3_f32 v22, v22, v204, v205
    v_max3_f32 v22, v22, v206, v207
    v_max3_f32 v22, v22, v208, v209
    v_max3_f32 v22, v22, v210, v211
    v_max3_f32 v22, v22, v212, v213
    v_max3_f32 v22, v22, v214, v215
    v_max3_f32 v23, v23, v216, v217
    v_max3_f32 v23, v23, v218, v219
    v_max3_f32 v23, v23, v220, v221
    v_max3_f32 v23, v23, v222, v223
    v_max3_f32 v23, v23, v224, v225
    v_max3_f32 v23, v23, v226, v227
    v_max3_f32 v23, v23, v228, v229
    v_max3_f32 v23, v23, v230, v231
    s_sub_u32 s12, s12, 1
    s_cmp_lg_u32 s12, 0
    s_cbranch_scc1 at_fbloop
    v_mov_b32 v152, v20
    v_mov_b32 v153, v21
    v_mov_b32 v154, v22
    v_mov_b32 v155, v23
    v_permlane32_swap_b32 v20, v152
    v_permlane32_swap_b32 v21, v153
    v_permlane32_swap_b32 v22, v154
    v_permlane32_swap_b32 v23, v155
    v_max_f32 v20, v20, v152
    v_max_f32 v21, v21, v153
    v_max_f32 v22, v22, v154
    v_max_f32 v23, v23, v155
    s_mov_b32 s14, s8
    buffer_load_dwordx4 v[56:59], v2, s[20:23], s14 offen
    buffer_load_dwordx2 v[60:61], v9, s[20:23], s14 offen
    buffer_load_dwordx4 v[88:91], v10, s[20:23], s14 offen
    buffer_load_dwordx4 v[92:95], v10, s[20:23], s14 offen offset:704
    s_add_u32 s14, s14, 2688
    buffer_load_dwordx4 v[64:67], v2, s[20:23], s14 offen
    buffer_load_dwordx2 v[68:69], v9, s[20:23], s14 offen
    buffer_load_dwordx4 v[96:99], v10, s[20:23], s14 offen
    buffer_load_dwordx4 v[100:103], v10, s[20:23], s14 offen offset:704
    s_add_u32 s14, s14, 2688
    buffer_load_dwordx4 v[72:75], v2, s[20:23], s14 offen
    buffer_load_dwordx2 v[76:77], v9, s[20:23], s14 offen
    buffer_load_dwordx4 v[104:107], v10, s[20:23], s14 offen
    buffer_load_dwordx4 v[108:111], v10, s[20:23], s14 offen offset:704
    s_add_u32 s14, s14, 2688
    s_branch at_setslots
at_store:
    buffer_store_dwordx4 v[120:123], v7, s[20:23], s18 offen sc1
    s_add_u32 s18, s18, 8192
    buffer_store_dwordx4 v[124:127], v7, s[20:23], s18 offen sc1
    s_cmp_ge_u32 s6, 2
    s_cbranch_scc1 at_st2
    s_add_u32 s18, s18, 8192
    buffer_store_dwordx4 v[128:131], v7, s[20:23], s18 offen sc1
at_st2:
    s_lshr_b32 s16, s3, 3
    s_lshl_b32 s16, s16, 10
    s_and_b32 s10, s3, 7
    s_lshl_b32 s10, s10, 2
    s_add_u32 s16, s16, s10
    s_add_u32 s16, s16, 7372800
    v_lshlrev_b32 v152, 7, v1
    v_add_u32 v152, s16, v152
    v_mov_b32 v153, 1
    s_waitcnt vmcnt(0)
    s_barrier
    s_cmp_lg_u32 s6, 0
    s_cbranch_scc1 at_done
    s_mov_b64 exec, 0xff
    global_store_dword v152, v153, s[4:5] sc1
    s_mov_b64 exec, -1
at_done:
    s_endpgm
k2_gemm:
    s_setprio 0
    s_sub_u32 s50, s2, 256
    s_and_b32 s51, s50, 7
    s_lshr_b32 s52, s50, 3
    s_lshr_b32 s17, s52, 3
    s_lshl_b32 s15, s51, 2
    s_add_u32 s15, s15, s17
    s_and_b32 s16, s52, 7
    s_add_u32 s49, s17, s16
    s_and_b32 s49, s49, 3
    s_load_dwordx2 s[4:5], s[0:1], 0
    s_load_dwordx2 s[6:7], s[0:1], 32
    s_load_dwordx4 s[8:11], s[0:1], 64
    s_load_dwordx4 s[40:43], s[0:1], 80
    v_and_b32 v1, 63, v0
    v_lshrrev_b32 v7, 6, v0
    v_and_b32 v2, 15, v1
    v_readfirstlane_b32 s14, v7
    v_lshrrev_b32 v3, 4, v1
    v_lshlrev_b32 v4, 4, v1
    v_add_u32 v7, 0, v1
    v_mul_u32_u24 v8, 6554, v7
    v_lshrrev_b32 v8, 16, v8
    v_mul_u32_u24 v9, 10, v8
    v_sub_u32 v9, v7, v9
    v_lshrrev_b32 v10, 1, v8
    v_and_b32 v10, 4, v10
    v_xor_b32 v8, v8, v10
    v_mul_u32_u24 v8, 1280, v8
    v_lshl_add_u32 v11, v9, 4, v8
    v_add_u32 v7, 64, v1
    v_mul_u32_u24 v8, 6554, v7
    v_lshrrev_b32 v8, 16, v8
    v_mul_u32_u24 v9, 10, v8
    v_sub_u32 v9, v7, v9
    v_lshrrev_b32 v10, 1, v8
    v_and_b32 v10, 4, v10
    v_xor_b32 v8, v8, v10
    v_mul_u32_u24 v8, 1280, v8
    v_lshl_add_u32 v12, v9, 4, v8
    v_add_u32 v7, 128, v1
    v_mul_u32_u24 v8, 6554, v7
    v_lshrrev_b32 v8, 16, v8
    v_mul_u32_u24 v9, 10, v8
    v_sub_u32 v9, v7, v9
    v_lshrrev_b32 v10, 1, v8
    v_and_b32 v10, 4, v10
    v_xor_b32 v8, v8, v10
    v_mul_u32_u24 v8, 1280, v8
    v_lshl_add_u32 v13, v9, 4, v8
    v_add_u32 v7, 192, v1
    v_mul_u32_u24 v8, 6554, v7
    v_lshrrev_b32 v8, 16, v8
    v_mul_u32_u24 v9, 10, v8
    v_sub_u32 v9, v7, v9
    v_lshrrev_b32 v10, 1, v8
    v_and_b32 v10, 4, v10
    v_xor_b32 v8, v8, v10
    v_mul_u32_u24 v8, 1280, v8
    v_lshl_add_u32 v14, v9, 4, v8
    v_add_u32 v7, 256, v1
    v_mul_u32_u24 v8, 6554, v7
    v_lshrrev_b32 v8, 16, v8
    v_mul_u32_u24 v9, 10, v8
    v_sub_u32 v9, v7, v9
    v_lshrrev_b32 v10, 1, v8
    v_and_b32 v10, 4, v10
    v_xor_b32 v8, v8, v10
    v_mul_u32_u24 v8, 1280, v8
    v_lshl_add_u32 v15, v9, 4, v8
    s_mul_i32 s19, s14, 20480
    v_lshrrev_b32 v7, 2, v2
    v_lshl_add_u32 v7, v3, 3, v7
    v_and_b32 v8, 1, v3
    v_lshlrev_b32 v8, 2, v8
    v_and_b32 v9, 3, v2
    v_lshlrev_b32 v9, 3, v9
    v_add_u32 v9, s19, v9
    v_xor_b32 v10, v7, v8
    v_mul_u32_u24 v5, 160, v10
    v_add_u32 v5, v5, v9
    v_xor_b32 v10, 4, v10
    v_mul_u32_u24 v6, 160, v10
    v_add_u32 v6, v6, v9
    s_add_u32 s17, s14, 0
    s_and_b32 s17, s17, 3
    s_mul_i32 s17, s17, 75776
    v_add_u32 v16, s17, v4
    s_add_u32 s17, s14, 1
    s_and_b32 s17, s17, 3
    s_mul_i32 s17, s17, 75776
    v_add_u32 v17, s17, v4
    s_add_u32 s17, s14, 2
    s_and_b32 s17, s17, 3
    s_mul_i32 s17, s17, 75776
    v_add_u32 v18, s17, v4
    s_add_u32 s17, s14, 3
    s_and_b32 s17, s17, 3
    s_mul_i32 s17, s17, 75776
    v_add_u32 v19, s17, v4
    s_cmp_lt_u32 s14, 2
    s_cselect_b32 s24, 15, 12
    s_mul_i32 s25, s14, 15
    s_mul_i32 s17, s14, 12
    s_add_u32 s17, s17, 6
    s_cmp_lt_u32 s14, 2
    s_cselect_b32 s25, s25, s17
    s_mul_i32 s26, s49, 3
    s_mov_b32 s27, s26
    s_add_u32 s17, s25, s26
    s_mul_i32 s28, s17, 40960
    s_mul_i32 s18, s16, 160
    s_add_u32 s28, s28, s18
    s_mul_i32 s29, s15, 303104
    s_add_u32 s29, s29, 8388608
    s_add_u32 s17, s17, 20
    s_lshl_b32 s17, s17, 10
    s_add_u32 s30, s29, s17
    s_sub_u32 s17, 1, s24
    s_mul_i32 s31, s17, 40960
    s_lshl_b32 s32, s17, 10
    s_waitcnt lgkmcnt(0)
    s_mov_b32 s20, s8
    s_mov_b32 s21, s9
    s_mov_b32 s22, 2211840
    s_mov_b32 s23, 0x00020000
    s_mov_b32 s44, s42
    s_mov_b32 s45, s43
    s_mov_b32 s46, 67108864
    s_mov_b32 s47, 0x00020000
    s_mov_b32 s12, s42
    s_mov_b32 s13, s43
    v_mov_b32 v20, 0
    v_mov_b32 v21, 0
    v_mov_b32 v22, 0
    v_mov_b32 v23, 0
    v_mov_b32 v24, 0
    v_mov_b32 v25, 0
    v_mov_b32 v26, 0
    v_mov_b32 v27, 0
    v_mov_b32 v28, 0
    v_mov_b32 v29, 0
    v_mov_b32 v30, 0
    v_mov_b32 v31, 0
    v_mov_b32 v32, 0
    v_mov_b32 v33, 0
    v_mov_b32 v34, 0
    v_mov_b32 v35, 0
    v_mov_b32 v36, 0
    v_mov_b32 v37, 0
    v_mov_b32 v38, 0
    v_mov_b32 v39, 0
    v_mov_b32 v40, 0
    v_mov_b32 v41, 0
    v_mov_b32 v42, 0
    v_mov_b32 v43, 0
    v_mov_b32 v44, 0
    v_mov_b32 v45, 0
    v_mov_b32 v46, 0
    v_mov_b32 v47, 0
    v_mov_b32 v48, 0
    v_mov_b32 v49, 0
    v_mov_b32 v50, 0
    v_mov_b32 v51, 0
    v_mov_b32 v52, 0
    v_mov_b32 v53, 0
    v_mov_b32 v54, 0
    v_mov_b32 v55, 0
    v_mov_b32 v56, 0
    v_mov_b32 v57, 0
    v_mov_b32 v58, 0
    v_mov_b32 v59, 0
    v_mov_b32 v60, 0
    v_mov_b32 v61, 0
    v_mov_b32 v62, 0
    v_mov_b32 v63, 0
    v_mov_b32 v64, 0
    v_mov_b32 v65, 0
    v_mov_b32 v66, 0
    v_mov_b32 v67, 0
    v_mov_b32 v68, 0
    v_mov_b32 v69, 0
    v_mov_b32 v70, 0
    v_mov_b32 v71, 0
    v_mov_b32 v72, 0
    v_mov_b32 v73, 0
    v_mov_b32 v74, 0
    v_mov_b32 v75, 0
    v_mov_b32 v76, 0
    v_mov_b32 v77, 0
    v_mov_b32 v78, 0
    v_mov_b32 v79, 0
    v_mov_b32 v80, 0
    v_mov_b32 v81, 0
    v_mov_b32 v82, 0
    v_mov_b32 v83, 0
    v_mov_b32 v84, 0
    v_mov_b32 v85, 0
    v_mov_b32 v86, 0
    v_mov_b32 v87, 0
    v_mov_b32 v88, 0
    v_mov_b32 v89, 0
    v_mov_b32 v90, 0
    v_mov_b32 v91, 0
    v_mov_b32 v92, 0
    v_mov_b32 v93, 0
    v_mov_b32 v94, 0
    v_mov_b32 v95, 0
    v_mov_b32 v96, 0
    v_mov_b32 v97, 0
    v_mov_b32 v98, 0
    v_mov_b32 v99, 0
    s_lshl_b32 s33, s15, 3
    s_add_u32 s33, s33, s16
    s_lshl_b32 s33, s33, 7
    s_add_u32 s35, s33, 7372800
    s_add_u32 s33, s33, 7340032
    s_add_u32 m0, s19, 0
    s_nop 0
    buffer_load_dwordx4 v11, s[20:23], s28 offen lds
    s_add_u32 m0, s19, 1024
    s_nop 0
    buffer_load_dwordx4 v12, s[20:23], s28 offen lds
    s_add_u32 m0, s19, 2048
    s_nop 0
    buffer_load_dwordx4 v13, s[20:23], s28 offen lds
    s_add_u32 m0, s19, 3072
    s_nop 0
    buffer_load_dwordx4 v14, s[20:23], s28 offen lds
    s_add_u32 m0, s19, 4096
    s_nop 0
    buffer_load_dwordx4 v15, s[20:23], s28 offen lds
    s_add_u32 s26, s26, 1
    s_cmp_eq_u32 s26, s24
    s_cselect_b32 s17, s31, 40960
    s_cselect_b32 s26, 0, s26
    s_add_u32 s28, s28, s17
    buffer_load_dwordx4 v[160:163], v16, s[44:47], s30 offen
    buffer_load_dwordx4 v[164:167], v17, s[44:47], s30 offen
    buffer_load_dwordx4 v[168:171], v18, s[44:47], s30 offen
    buffer_load_dwordx4 v[172:175], v19, s[44:47], s30 offen
    s_add_u32 s27, s27, 1
    s_cmp_eq_u32 s27, s24
    s_cselect_b32 s17, s32, 1024
    s_cselect_b32 s27, 0, s27
    s_add_u32 s30, s30, s17
    s_cmp_eq_u32 s24, 15
    s_cselect_b32 s34, 4, 3
    s_waitcnt vmcnt(0)
    s_add_u32 m0, s19, 5120
    s_nop 0
    buffer_load_dwordx4 v11, s[20:23], s28 offen lds
    s_add_u32 m0, s19, 6144
    s_nop 0
    buffer_load_dwordx4 v12, s[20:23], s28 offen lds
    s_add_u32 m0, s19, 7168
    s_nop 0
    buffer_load_dwordx4 v13, s[20:23], s28 offen lds
    s_add_u32 m0, s19, 8192
    s_nop 0
    buffer_load_dwordx4 v14, s[20:23], s28 offen lds
    s_add_u32 m0, s19, 9216
    s_nop 0
    buffer_load_dwordx4 v15, s[20:23], s28 offen lds
    s_add_u32 s26, s26, 1
    s_cmp_eq_u32 s26, s24
    s_cselect_b32 s17, s31, 40960
    s_cselect_b32 s26, 0, s26
    s_add_u32 s28, s28, s17
    buffer_load_dwordx4 v[176:179], v16, s[44:47], s30 offen
    buffer_load_dwordx4 v[180:183], v17, s[44:47], s30 offen
    buffer_load_dwordx4 v[184:187], v18, s[44:47], s30 offen
    buffer_load_dwordx4 v[188:191], v19, s[44:47], s30 offen
    s_add_u32 s27, s27, 1
    s_cmp_eq_u32 s27, s24
    s_cselect_b32 s17, s32, 1024
    s_cselect_b32 s27, 0, s27
    s_add_u32 s30, s30, s17
    ds_read_b64_tr_b16 v[100:101], v5 offset:0
    ds_read_b64_tr_b16 v[102:103], v6 offset:0
    ds_read_b64_tr_b16 v[104:105], v5 offset:32
    ds_read_b64_tr_b16 v[106:107], v6 offset:32
    ds_read_b64_tr_b16 v[108:109], v5 offset:64
    ds_read_b64_tr_b16 v[110:111], v6 offset:64
    ds_read_b64_tr_b16 v[112:113], v5 offset:96
    ds_read_b64_tr_b16 v[114:115], v6 offset:96
    ds_read_b64_tr_b16 v[116:117], v5 offset:128
    ds_read_b64_tr_b16 v[118:119], v6 offset:128
g2_loop:
    s_waitcnt lgkmcnt(0)
    v_mfma_f32_16x16x32_bf16 v[20:23], v[100:103], v[160:163], v[20:23]
    v_mfma_f32_16x16x32_bf16 v[24:27], v[104:107], v[160:163], v[24:27]
    v_mfma_f32_16x16x32_bf16 v[28:31], v[108:111], v[160:163], v[28:31]
    v_mfma_f32_16x16x32_bf16 v[32:35], v[112:115], v[160:163], v[32:35]
    v_mfma_f32_16x16x32_bf16 v[36:39], v[116:119], v[160:163], v[36:39]
    v_mfma_f32_16x16x32_bf16 v[40:43], v[100:103], v[164:167], v[40:43]
    v_mfma_f32_16x16x32_bf16 v[44:47], v[104:107], v[164:167], v[44:47]
    v_mfma_f32_16x16x32_bf16 v[48:51], v[108:111], v[164:167], v[48:51]
    v_mfma_f32_16x16x32_bf16 v[52:55], v[112:115], v[164:167], v[52:55]
    v_mfma_f32_16x16x32_bf16 v[56:59], v[116:119], v[164:167], v[56:59]
    v_mfma_f32_16x16x32_bf16 v[60:63], v[100:103], v[168:171], v[60:63]
    v_mfma_f32_16x16x32_bf16 v[64:67], v[104:107], v[168:171], v[64:67]
    v_mfma_f32_16x16x32_bf16 v[68:71], v[108:111], v[168:171], v[68:71]
    v_mfma_f32_16x16x32_bf16 v[72:75], v[112:115], v[168:171], v[72:75]
    v_mfma_f32_16x16x32_bf16 v[76:79], v[116:119], v[168:171], v[76:79]
    v_mfma_f32_16x16x32_bf16 v[80:83], v[100:103], v[172:175], v[80:83]
    v_mfma_f32_16x16x32_bf16 v[84:87], v[104:107], v[172:175], v[84:87]
    v_mfma_f32_16x16x32_bf16 v[88:91], v[108:111], v[172:175], v[88:91]
    v_mfma_f32_16x16x32_bf16 v[92:95], v[112:115], v[172:175], v[92:95]
    v_mfma_f32_16x16x32_bf16 v[96:99], v[116:119], v[172:175], v[96:99]
    s_waitcnt vmcnt(0)
    ds_read_b64_tr_b16 v[120:121], v5 offset:5120
    ds_read_b64_tr_b16 v[122:123], v6 offset:5120
    ds_read_b64_tr_b16 v[124:125], v5 offset:5152
    ds_read_b64_tr_b16 v[126:127], v6 offset:5152
    ds_read_b64_tr_b16 v[128:129], v5 offset:5184
    ds_read_b64_tr_b16 v[130:131], v6 offset:5184
    ds_read_b64_tr_b16 v[132:133], v5 offset:5216
    ds_read_b64_tr_b16 v[134:135], v6 offset:5216
    ds_read_b64_tr_b16 v[136:137], v5 offset:5248
    ds_read_b64_tr_b16 v[138:139], v6 offset:5248
    s_add_u32 m0, s19, 10240
    s_nop 0
    buffer_load_dwordx4 v11, s[20:23], s28 offen lds
    s_add_u32 m0, s19, 11264
    s_nop 0
    buffer_load_dwordx4 v12, s[20:23], s28 offen lds
    s_add_u32 m0, s19, 12288
    s_nop 0
    buffer_load_dwordx4 v13, s[20:23], s28 offen lds
    s_add_u32 m0, s19, 13312
    s_nop 0
    buffer_load_dwordx4 v14, s[20:23], s28 offen lds
    s_add_u32 m0, s19, 14336
    s_nop 0
    buffer_load_dwordx4 v15, s[20:23], s28 offen lds
    s_add_u32 s26, s26, 1
    s_cmp_eq_u32 s26, s24
    s_cselect_b32 s17, s31, 40960
    s_cselect_b32 s26, 0, s26
    s_add_u32 s28, s28, s17
    buffer_load_dwordx4 v[192:195], v16, s[44:47], s30 offen
    buffer_load_dwordx4 v[196:199], v17, s[44:47], s30 offen
    buffer_load_dwordx4 v[200:203], v18, s[44:47], s30 offen
    buffer_load_dwordx4 v[204:207], v19, s[44:47], s30 offen
    s_add_u32 s27, s27, 1
    s_cmp_eq_u32 s27, s24
    s_cselect_b32 s17, s32, 1024
    s_cselect_b32 s27, 0, s27
    s_add_u32 s30, s30, s17
    s_waitcnt lgkmcnt(0)
    v_mfma_f32_16x16x32_bf16 v[20:23], v[120:123], v[176:179], v[20:23]
    v_mfma_f32_16x16x32_bf16 v[24:27], v[124:127], v[176:179], v[24:27]
    v_mfma_f32_16x16x32_bf16 v[28:31], v[128:131], v[176:179], v[28:31]
    v_mfma_f32_16x16x32_bf16 v[32:35], v[132:135], v[176:179], v[32:35]
    v_mfma_f32_16x16x32_bf16 v[36:39], v[136:139], v[176:179], v[36:39]
    v_mfma_f32_16x16x32_bf16 v[40:43], v[120:123], v[180:183], v[40:43]
    v_mfma_f32_16x16x32_bf16 v[44:47], v[124:127], v[180:183], v[44:47]
    v_mfma_f32_16x16x32_bf16 v[48:51], v[128:131], v[180:183], v[48:51]
    v_mfma_f32_16x16x32_bf16 v[52:55], v[132:135], v[180:183], v[52:55]
    v_mfma_f32_16x16x32_bf16 v[56:59], v[136:139], v[180:183], v[56:59]
    v_mfma_f32_16x16x32_bf16 v[60:63], v[120:123], v[184:187], v[60:63]
    v_mfma_f32_16x16x32_bf16 v[64:67], v[124:127], v[184:187], v[64:67]
    v_mfma_f32_16x16x32_bf16 v[68:71], v[128:131], v[184:187], v[68:71]
    v_mfma_f32_16x16x32_bf16 v[72:75], v[132:135], v[184:187], v[72:75]
    v_mfma_f32_16x16x32_bf16 v[76:79], v[136:139], v[184:187], v[76:79]
    v_mfma_f32_16x16x32_bf16 v[80:83], v[120:123], v[188:191], v[80:83]
    v_mfma_f32_16x16x32_bf16 v[84:87], v[124:127], v[188:191], v[84:87]
    v_mfma_f32_16x16x32_bf16 v[88:91], v[128:131], v[188:191], v[88:91]
    v_mfma_f32_16x16x32_bf16 v[92:95], v[132:135], v[188:191], v[92:95]
    v_mfma_f32_16x16x32_bf16 v[96:99], v[136:139], v[188:191], v[96:99]
    s_waitcnt vmcnt(0)
    ds_read_b64_tr_b16 v[140:141], v5 offset:10240
    ds_read_b64_tr_b16 v[142:143], v6 offset:10240
    ds_read_b64_tr_b16 v[144:145], v5 offset:10272
    ds_read_b64_tr_b16 v[146:147], v6 offset:10272
    ds_read_b64_tr_b16 v[148:149], v5 offset:10304
    ds_read_b64_tr_b16 v[150:151], v6 offset:10304
    ds_read_b64_tr_b16 v[152:153], v5 offset:10336
    ds_read_b64_tr_b16 v[154:155], v6 offset:10336
    ds_read_b64_tr_b16 v[156:157], v5 offset:10368
    ds_read_b64_tr_b16 v[158:159], v6 offset:10368
    s_add_u32 m0, s19, 0
    s_nop 0
    buffer_load_dwordx4 v11, s[20:23], s28 offen lds
    s_add_u32 m0, s19, 1024
    s_nop 0
    buffer_load_dwordx4 v12, s[20:23], s28 offen lds
    s_add_u32 m0, s19, 2048
    s_nop 0
    buffer_load_dwordx4 v13, s[20:23], s28 offen lds
    s_add_u32 m0, s19, 3072
    s_nop 0
    buffer_load_dwordx4 v14, s[20:23], s28 offen lds
    s_add_u32 m0, s19, 4096
    s_nop 0
    buffer_load_dwordx4 v15, s[20:23], s28 offen lds
    s_add_u32 s26, s26, 1
    s_cmp_eq_u32 s26, s24
    s_cselect_b32 s17, s31, 40960
    s_cselect_b32 s26, 0, s26
    s_add_u32 s28, s28, s17
    buffer_load_dwordx4 v[160:163], v16, s[44:47], s30 offen
    buffer_load_dwordx4 v[164:167], v17, s[44:47], s30 offen
    buffer_load_dwordx4 v[168:171], v18, s[44:47], s30 offen
    buffer_load_dwordx4 v[172:175], v19, s[44:47], s30 offen
    s_add_u32 s27, s27, 1
    s_cmp_eq_u32 s27, s24
    s_cselect_b32 s17, s32, 1024
    s_cselect_b32 s27, 0, s27
    s_add_u32 s30, s30, s17
    s_waitcnt lgkmcnt(0)
    v_mfma_f32_16x16x32_bf16 v[20:23], v[140:143], v[192:195], v[20:23]
    v_mfma_f32_16x16x32_bf16 v[24:27], v[144:147], v[192:195], v[24:27]
    v_mfma_f32_16x16x32_bf16 v[28:31], v[148:151], v[192:195], v[28:31]
    v_mfma_f32_16x16x32_bf16 v[32:35], v[152:155], v[192:195], v[32:35]
    v_mfma_f32_16x16x32_bf16 v[36:39], v[156:159], v[192:195], v[36:39]
    v_mfma_f32_16x16x32_bf16 v[40:43], v[140:143], v[196:199], v[40:43]
    v_mfma_f32_16x16x32_bf16 v[44:47], v[144:147], v[196:199], v[44:47]
    v_mfma_f32_16x16x32_bf16 v[48:51], v[148:151], v[196:199], v[48:51]
    v_mfma_f32_16x16x32_bf16 v[52:55], v[152:155], v[196:199], v[52:55]
    v_mfma_f32_16x16x32_bf16 v[56:59], v[156:159], v[196:199], v[56:59]
    v_mfma_f32_16x16x32_bf16 v[60:63], v[140:143], v[200:203], v[60:63]
    v_mfma_f32_16x16x32_bf16 v[64:67], v[144:147], v[200:203], v[64:67]
    v_mfma_f32_16x16x32_bf16 v[68:71], v[148:151], v[200:203], v[68:71]
    v_mfma_f32_16x16x32_bf16 v[72:75], v[152:155], v[200:203], v[72:75]
    v_mfma_f32_16x16x32_bf16 v[76:79], v[156:159], v[200:203], v[76:79]
    v_mfma_f32_16x16x32_bf16 v[80:83], v[140:143], v[204:207], v[80:83]
    v_mfma_f32_16x16x32_bf16 v[84:87], v[144:147], v[204:207], v[84:87]
    v_mfma_f32_16x16x32_bf16 v[88:91], v[148:151], v[204:207], v[88:91]
    v_mfma_f32_16x16x32_bf16 v[92:95], v[152:155], v[204:207], v[92:95]
    v_mfma_f32_16x16x32_bf16 v[96:99], v[156:159], v[204:207], v[96:99]
    s_waitcnt vmcnt(0)
    ds_read_b64_tr_b16 v[100:101], v5 offset:0
    ds_read_b64_tr_b16 v[102:103], v6 offset:0
    ds_read_b64_tr_b16 v[104:105], v5 offset:32
    ds_read_b64_tr_b16 v[106:107], v6 offset:32
    ds_read_b64_tr_b16 v[108:109], v5 offset:64
    ds_read_b64_tr_b16 v[110:111], v6 offset:64
    ds_read_b64_tr_b16 v[112:113], v5 offset:96
    ds_read_b64_tr_b16 v[114:115], v6 offset:96
    ds_read_b64_tr_b16 v[116:117], v5 offset:128
    ds_read_b64_tr_b16 v[118:119], v6 offset:128
    s_add_u32 m0, s19, 5120
    s_nop 0
    buffer_load_dwordx4 v11, s[20:23], s28 offen lds
    s_add_u32 m0, s19, 6144
    s_nop 0
    buffer_load_dwordx4 v12, s[20:23], s28 offen lds
    s_add_u32 m0, s19, 7168
    s_nop 0
    buffer_load_dwordx4 v13, s[20:23], s28 offen lds
    s_add_u32 m0, s19, 8192
    s_nop 0
    buffer_load_dwordx4 v14, s[20:23], s28 offen lds
    s_add_u32 m0, s19, 9216
    s_nop 0
    buffer_load_dwordx4 v15, s[20:23], s28 offen lds
    s_add_u32 s26, s26, 1
    s_cmp_eq_u32 s26, s24
    s_cselect_b32 s17, s31, 40960
    s_cselect_b32 s26, 0, s26
    s_add_u32 s28, s28, s17
    buffer_load_dwordx4 v[176:179], v16, s[44:47], s30 offen
    buffer_load_dwordx4 v[180:183], v17, s[44:47], s30 offen
    buffer_load_dwordx4 v[184:187], v18, s[44:47], s30 offen
    buffer_load_dwordx4 v[188:191], v19, s[44:47], s30 offen
    s_add_u32 s27, s27, 1
    s_cmp_eq_u32 s27, s24
    s_cselect_b32 s17, s32, 1024
    s_cselect_b32 s27, 0, s27
    s_add_u32 s30, s30, s17
    s_sub_u32 s34, s34, 1
    s_cmp_lg_u32 s34, 0
    s_cbranch_scc1 g2_loop
    s_waitcnt lgkmcnt(0)
    v_mfma_f32_16x16x32_bf16 v[20:23], v[100:103], v[160:163], v[20:23]
    v_mfma_f32_16x16x32_bf16 v[24:27], v[104:107], v[160:163], v[24:27]
    v_mfma_f32_16x16x32_bf16 v[28:31], v[108:111], v[160:163], v[28:31]
    v_mfma_f32_16x16x32_bf16 v[32:35], v[112:115], v[160:163], v[32:35]
    v_mfma_f32_16x16x32_bf16 v[36:39], v[116:119], v[160:163], v[36:39]
    v_mfma_f32_16x16x32_bf16 v[40:43], v[100:103], v[164:167], v[40:43]
    v_mfma_f32_16x16x32_bf16 v[44:47], v[104:107], v[164:167], v[44:47]
    v_mfma_f32_16x16x32_bf16 v[48:51], v[108:111], v[164:167], v[48:51]
    v_mfma_f32_16x16x32_bf16 v[52:55], v[112:115], v[164:167], v[52:55]
    v_mfma_f32_16x16x32_bf16 v[56:59], v[116:119], v[164:167], v[56:59]
    v_mfma_f32_16x16x32_bf16 v[60:63], v[100:103], v[168:171], v[60:63]
    v_mfma_f32_16x16x32_bf16 v[64:67], v[104:107], v[168:171], v[64:67]
    v_mfma_f32_16x16x32_bf16 v[68:71], v[108:111], v[168:171], v[68:71]
    v_mfma_f32_16x16x32_bf16 v[72:75], v[112:115], v[168:171], v[72:75]
    v_mfma_f32_16x16x32_bf16 v[76:79], v[116:119], v[168:171], v[76:79]
    v_mfma_f32_16x16x32_bf16 v[80:83], v[100:103], v[172:175], v[80:83]
    v_mfma_f32_16x16x32_bf16 v[84:87], v[104:107], v[172:175], v[84:87]
    v_mfma_f32_16x16x32_bf16 v[88:91], v[108:111], v[172:175], v[88:91]
    v_mfma_f32_16x16x32_bf16 v[92:95], v[112:115], v[172:175], v[92:95]
    v_mfma_f32_16x16x32_bf16 v[96:99], v[116:119], v[172:175], v[96:99]
    s_waitcnt vmcnt(0)
    ds_read_b64_tr_b16 v[120:121], v5 offset:5120
    ds_read_b64_tr_b16 v[122:123], v6 offset:5120
    ds_read_b64_tr_b16 v[124:125], v5 offset:5152
    ds_read_b64_tr_b16 v[126:127], v6 offset:5152
    ds_read_b64_tr_b16 v[128:129], v5 offset:5184
    ds_read_b64_tr_b16 v[130:131], v6 offset:5184
    ds_read_b64_tr_b16 v[132:133], v5 offset:5216
    ds_read_b64_tr_b16 v[134:135], v6 offset:5216
    ds_read_b64_tr_b16 v[136:137], v5 offset:5248
    ds_read_b64_tr_b16 v[138:139], v6 offset:5248
    s_add_u32 m0, s19, 10240
    s_nop 0
    buffer_load_dwordx4 v11, s[20:23], s28 offen lds
    s_add_u32 m0, s19, 11264
    s_nop 0
    buffer_load_dwordx4 v12, s[20:23], s28 offen lds
    s_add_u32 m0, s19, 12288
    s_nop 0
    buffer_load_dwordx4 v13, s[20:23], s28 offen lds
    s_add_u32 m0, s19, 13312
    s_nop 0
    buffer_load_dwordx4 v14, s[20:23], s28 offen lds
    s_add_u32 m0, s19, 14336
    s_nop 0
    buffer_load_dwordx4 v15, s[20:23], s28 offen lds
    s_add_u32 s26, s26, 1
    s_cmp_eq_u32 s26, s24
    s_cselect_b32 s17, s31, 40960
    s_cselect_b32 s26, 0, s26
    s_add_u32 s28, s28, s17
    buffer_load_dwordx4 v[192:195], v16, s[44:47], s30 offen
    buffer_load_dwordx4 v[196:199], v17, s[44:47], s30 offen
    buffer_load_dwordx4 v[200:203], v18, s[44:47], s30 offen
    buffer_load_dwordx4 v[204:207], v19, s[44:47], s30 offen
    s_add_u32 s27, s27, 1
    s_cmp_eq_u32 s27, s24
    s_cselect_b32 s17, s32, 1024
    s_cselect_b32 s27, 0, s27
    s_add_u32 s30, s30, s17
    s_waitcnt lgkmcnt(0)
    v_mfma_f32_16x16x32_bf16 v[20:23], v[120:123], v[176:179], v[20:23]
    v_mfma_f32_16x16x32_bf16 v[24:27], v[124:127], v[176:179], v[24:27]
    v_mfma_f32_16x16x32_bf16 v[28:31], v[128:131], v[176:179], v[28:31]
    v_mfma_f32_16x16x32_bf16 v[32:35], v[132:135], v[176:179], v[32:35]
    v_mfma_f32_16x16x32_bf16 v[36:39], v[136:139], v[176:179], v[36:39]
    v_mfma_f32_16x16x32_bf16 v[40:43], v[120:123], v[180:183], v[40:43]
    v_mfma_f32_16x16x32_bf16 v[44:47], v[124:127], v[180:183], v[44:47]
    v_mfma_f32_16x16x32_bf16 v[48:51], v[128:131], v[180:183], v[48:51]
    v_mfma_f32_16x16x32_bf16 v[52:55], v[132:135], v[180:183], v[52:55]
    v_mfma_f32_16x16x32_bf16 v[56:59], v[136:139], v[180:183], v[56:59]
    v_mfma_f32_16x16x32_bf16 v[60:63], v[120:123], v[184:187], v[60:63]
    v_mfma_f32_16x16x32_bf16 v[64:67], v[124:127], v[184:187], v[64:67]
    v_mfma_f32_16x16x32_bf16 v[68:71], v[128:131], v[184:187], v[68:71]
    v_mfma_f32_16x16x32_bf16 v[72:75], v[132:135], v[184:187], v[72:75]
    v_mfma_f32_16x16x32_bf16 v[76:79], v[136:139], v[184:187], v[76:79]
    v_mfma_f32_16x16x32_bf16 v[80:83], v[120:123], v[188:191], v[80:83]
    v_mfma_f32_16x16x32_bf16 v[84:87], v[124:127], v[188:191], v[84:87]
    v_mfma_f32_16x16x32_bf16 v[88:91], v[128:131], v[188:191], v[88:91]
    v_mfma_f32_16x16x32_bf16 v[92:95], v[132:135], v[188:191], v[92:95]
    v_mfma_f32_16x16x32_bf16 v[96:99], v[136:139], v[188:191], v[96:99]
    s_waitcnt vmcnt(0)
    ds_read_b64_tr_b16 v[140:141], v5 offset:10240
    ds_read_b64_tr_b16 v[142:143], v6 offset:10240
    ds_read_b64_tr_b16 v[144:145], v5 offset:10272
    ds_read_b64_tr_b16 v[146:147], v6 offset:10272
    ds_read_b64_tr_b16 v[148:149], v5 offset:10304
    ds_read_b64_tr_b16 v[150:151], v6 offset:10304
    ds_read_b64_tr_b16 v[152:153], v5 offset:10336
    ds_read_b64_tr_b16 v[154:155], v6 offset:10336
    ds_read_b64_tr_b16 v[156:157], v5 offset:10368
    ds_read_b64_tr_b16 v[158:159], v6 offset:10368
    s_waitcnt lgkmcnt(0)
    v_mfma_f32_16x16x32_bf16 v[20:23], v[140:143], v[192:195], v[20:23]
    v_mfma_f32_16x16x32_bf16 v[24:27], v[144:147], v[192:195], v[24:27]
    v_mfma_f32_16x16x32_bf16 v[28:31], v[148:151], v[192:195], v[28:31]
    v_mfma_f32_16x16x32_bf16 v[32:35], v[152:155], v[192:195], v[32:35]
    v_mfma_f32_16x16x32_bf16 v[36:39], v[156:159], v[192:195], v[36:39]
    v_mfma_f32_16x16x32_bf16 v[40:43], v[140:143], v[196:199], v[40:43]
    v_mfma_f32_16x16x32_bf16 v[44:47], v[144:147], v[196:199], v[44:47]
    v_mfma_f32_16x16x32_bf16 v[48:51], v[148:151], v[196:199], v[48:51]
    v_mfma_f32_16x16x32_bf16 v[52:55], v[152:155], v[196:199], v[52:55]
    v_mfma_f32_16x16x32_bf16 v[56:59], v[156:159], v[196:199], v[56:59]
    v_mfma_f32_16x16x32_bf16 v[60:63], v[140:143], v[200:203], v[60:63]
    v_mfma_f32_16x16x32_bf16 v[64:67], v[144:147], v[200:203], v[64:67]
    v_mfma_f32_16x16x32_bf16 v[68:71], v[148:151], v[200:203], v[68:71]
    v_mfma_f32_16x16x32_bf16 v[72:75], v[152:155], v[200:203], v[72:75]
    v_mfma_f32_16x16x32_bf16 v[76:79], v[156:159], v[200:203], v[76:79]
    v_mfma_f32_16x16x32_bf16 v[80:83], v[140:143], v[204:207], v[80:83]
    v_mfma_f32_16x16x32_bf16 v[84:87], v[144:147], v[204:207], v[84:87]
    v_mfma_f32_16x16x32_bf16 v[88:91], v[148:151], v[204:207], v[88:91]
    v_mfma_f32_16x16x32_bf16 v[92:95], v[152:155], v[204:207], v[92:95]
    v_mfma_f32_16x16x32_bf16 v[96:99], v[156:159], v[204:207], v[96:99]
    s_lshl_b32 s17, s15, 2
    s_add_u32 s17, s17, s14
    s_mul_i32 s17, s17, 20480
    s_mul_i32 s18, s16, 160
    s_add_u32 s17, s17, s18
    s_add_u32 s36, s4, s17
    s_addc_u32 s37, s5, 0
    s_add_u32 s38, s10, s17
    s_addc_u32 s39, s11, 0
    v_mul_u32_u24 v10, 1280, v2
    v_lshl_add_u32 v10, v3, 3, v10
    global_load_dwordx2 v[240:241], v10, s[36:37] offset:0
    global_load_dwordx2 v[242:243], v10, s[36:37] offset:32
    global_load_dwordx2 v[244:245], v10, s[36:37] offset:64
    global_load_dwordx2 v[246:247], v10, s[36:37] offset:96
    global_load_dwordx2 v[248:249], v10, s[36:37] offset:128
    v_add_u32 v7, s19, v4
    ds_write_b128 v7, v[40:43] offset:0
    ds_write_b128 v7, v[44:47] offset:1024
    ds_write_b128 v7, v[48:51] offset:2048
    ds_write_b128 v7, v[52:55] offset:3072
    ds_write_b128 v7, v[56:59] offset:4096
    ds_write_b128 v7, v[60:63] offset:5120
    ds_write_b128 v7, v[64:67] offset:6144
    ds_write_b128 v7, v[68:71] offset:7168
    ds_write_b128 v7, v[72:75] offset:8192
    ds_write_b128 v7, v[76:79] offset:9216
    ds_write_b128 v7, v[80:83] offset:10240
    ds_write_b128 v7, v[84:87] offset:11264
    ds_write_b128 v7, v[88:91] offset:12288
    ds_write_b128 v7, v[92:95] offset:13312
    ds_write_b128 v7, v[96:99] offset:14336
    s_waitcnt lgkmcnt(0)
    s_barrier
    s_add_u32 s17, s14, 1
    s_and_b32 s17, s17, 3
    s_mul_i32 s17, s17, 20480
    v_add_u32 v7, s17, v4
    ds_read_b128 v[40:43], v7 offset:10240
    ds_read_b128 v[44:47], v7 offset:11264
    ds_read_b128 v[48:51], v7 offset:12288
    ds_read_b128 v[52:55], v7 offset:13312
    ds_read_b128 v[56:59], v7 offset:14336
    s_add_u32 s17, s14, 2
    s_and_b32 s17, s17, 3
    s_mul_i32 s17, s17, 20480
    v_add_u32 v7, s17, v4
    ds_read_b128 v[60:63], v7 offset:5120
    ds_read_b128 v[64:67], v7 offset:6144
    ds_read_b128 v[68:71], v7 offset:7168
    ds_read_b128 v[72:75], v7 offset:8192
    ds_read_b128 v[76:79], v7 offset:9216
    s_add_u32 s17, s14, 3
    s_and_b32 s17, s17, 3
    s_mul_i32 s17, s17, 20480
    v_add_u32 v7, s17, v4
    ds_read_b128 v[80:83], v7 offset:0
    ds_read_b128 v[84:87], v7 offset:1024
    ds_read_b128 v[88:91], v7 offset:2048
    ds_read_b128 v[92:95], v7 offset:3072
    ds_read_b128 v[96:99], v7 offset:4096
    s_mov_b32 s17, 0xffff0000
    s_waitcnt lgkmcnt(0) vmcnt(0)
    s_barrier
    s_mov_b32 s20, s6
    s_mov_b32 s21, s7
    s_mov_b32 s22, 819200
    s_add_u32 s28, s14, 16
    s_mul_i32 s28, s28, 40960
    s_mul_i32 s18, s16, 160
    s_add_u32 s28, s28, s18
    s_mul_i32 s26, s14, 5120
    s_add_u32 m0, s26, 0
    s_nop 0
    buffer_load_dwordx4 v11, s[20:23], s28 offen lds
    s_add_u32 m0, s26, 1024
    s_nop 0
    buffer_load_dwordx4 v12, s[20:23], s28 offen lds
    s_add_u32 m0, s26, 2048
    s_nop 0
    buffer_load_dwordx4 v13, s[20:23], s28 offen lds
    s_add_u32 m0, s26, 3072
    s_nop 0
    buffer_load_dwordx4 v14, s[20:23], s28 offen lds
    s_add_u32 m0, s26, 4096
    s_nop 0
    buffer_load_dwordx4 v15, s[20:23], s28 offen lds
    v_add_f32 v20, v20, v40
    v_add_f32 v60, v60, v80
    v_lshlrev_b32 v9, 16, v240
    v_add_f32 v20, v20, v60
    v_add_f32 v20, v20, v9
    v_add_f32 v21, v21, v41
    v_add_f32 v61, v61, v81
    v_and_b32 v9, s17, v240
    v_add_f32 v21, v21, v61
    v_add_f32 v21, v21, v9
    v_add_f32 v22, v22, v42
    v_add_f32 v62, v62, v82
    v_lshlrev_b32 v9, 16, v241
    v_add_f32 v22, v22, v62
    v_add_f32 v22, v22, v9
    v_add_f32 v23, v23, v43
    v_add_f32 v63, v63, v83
    v_and_b32 v9, s17, v241
    v_add_f32 v23, v23, v63
    v_add_f32 v23, v23, v9
    v_add_f32 v24, v24, v44
    v_add_f32 v64, v64, v84
    v_lshlrev_b32 v9, 16, v242
    v_add_f32 v24, v24, v64
    v_add_f32 v24, v24, v9
    v_add_f32 v25, v25, v45
    v_add_f32 v65, v65, v85
    v_and_b32 v9, s17, v242
    v_add_f32 v25, v25, v65
    v_add_f32 v25, v25, v9
    v_add_f32 v26, v26, v46
    v_add_f32 v66, v66, v86
    v_lshlrev_b32 v9, 16, v243
    v_add_f32 v26, v26, v66
    v_add_f32 v26, v26, v9
    v_add_f32 v27, v27, v47
    v_add_f32 v67, v67, v87
    v_and_b32 v9, s17, v243
    v_add_f32 v27, v27, v67
    v_add_f32 v27, v27, v9
    v_add_f32 v28, v28, v48
    v_add_f32 v68, v68, v88
    v_lshlrev_b32 v9, 16, v244
    v_add_f32 v28, v28, v68
    v_add_f32 v28, v28, v9
    v_add_f32 v29, v29, v49
    v_add_f32 v69, v69, v89
    v_and_b32 v9, s17, v244
    v_add_f32 v29, v29, v69
    v_add_f32 v29, v29, v9
    v_add_f32 v30, v30, v50
    v_add_f32 v70, v70, v90
    v_lshlrev_b32 v9, 16, v245
    v_add_f32 v30, v30, v70
    v_add_f32 v30, v30, v9
    v_add_f32 v31, v31, v51
    v_add_f32 v71, v71, v91
    v_and_b32 v9, s17, v245
    v_add_f32 v31, v31, v71
    v_add_f32 v31, v31, v9
    v_add_f32 v32, v32, v52
    v_add_f32 v72, v72, v92
    v_lshlrev_b32 v9, 16, v246
    v_add_f32 v32, v32, v72
    v_add_f32 v32, v32, v9
    v_add_f32 v33, v33, v53
    v_add_f32 v73, v73, v93
    v_and_b32 v9, s17, v246
    v_add_f32 v33, v33, v73
    v_add_f32 v33, v33, v9
    v_add_f32 v34, v34, v54
    v_add_f32 v74, v74, v94
    v_lshlrev_b32 v9, 16, v247
    v_add_f32 v34, v34, v74
    v_add_f32 v34, v34, v9
    v_add_f32 v35, v35, v55
    v_add_f32 v75, v75, v95
    v_and_b32 v9, s17, v247
    v_add_f32 v35, v35, v75
    v_add_f32 v35, v35, v9
    v_add_f32 v36, v36, v56
    v_add_f32 v76, v76, v96
    v_lshlrev_b32 v9, 16, v248
    v_add_f32 v36, v36, v76
    v_add_f32 v36, v36, v9
    v_add_f32 v37, v37, v57
    v_add_f32 v77, v77, v97
    v_and_b32 v9, s17, v248
    v_add_f32 v37, v37, v77
    v_add_f32 v37, v37, v9
    v_add_f32 v38, v38, v58
    v_add_f32 v78, v78, v98
    v_lshlrev_b32 v9, 16, v249
    v_add_f32 v38, v38, v78
    v_add_f32 v38, v38, v9
    v_add_f32 v39, v39, v59
    v_add_f32 v79, v79, v99
    v_and_b32 v9, s17, v249
    v_add_f32 v39, v39, v79
    v_add_f32 v39, v39, v9
    v_subrev_u32 v5, s19, v5
    v_subrev_u32 v6, s19, v6
    v_add_u32 v17, 40960, v5
    v_add_u32 v18, 40960, v6
    s_waitcnt vmcnt(0)
    s_barrier
    ds_read_b64_tr_b16 v[40:41], v5 offset:0
    ds_read_b64_tr_b16 v[42:43], v6 offset:0
    ds_read_b64_tr_b16 v[44:45], v5 offset:32
    ds_read_b64_tr_b16 v[46:47], v6 offset:32
    ds_read_b64_tr_b16 v[48:49], v5 offset:64
    ds_read_b64_tr_b16 v[50:51], v6 offset:64
    ds_read_b64_tr_b16 v[52:53], v5 offset:96
    ds_read_b64_tr_b16 v[54:55], v6 offset:96
    ds_read_b64_tr_b16 v[56:57], v5 offset:128
    ds_read_b64_tr_b16 v[58:59], v6 offset:128
    ds_read_b64_tr_b16 v[60:61], v5 offset:5120
    ds_read_b64_tr_b16 v[62:63], v6 offset:5120
    ds_read_b64_tr_b16 v[64:65], v5 offset:5152
    ds_read_b64_tr_b16 v[66:67], v6 offset:5152
    ds_read_b64_tr_b16 v[68:69], v5 offset:5184
    ds_read_b64_tr_b16 v[70:71], v6 offset:5184
    ds_read_b64_tr_b16 v[72:73], v5 offset:5216
    ds_read_b64_tr_b16 v[74:75], v6 offset:5216
    ds_read_b64_tr_b16 v[76:77], v5 offset:5248
    ds_read_b64_tr_b16 v[78:79], v6 offset:5248
    ds_read_b64_tr_b16 v[80:81], v5 offset:10240
    ds_read_b64_tr_b16 v[82:83], v6 offset:10240
    ds_read_b64_tr_b16 v[84:85], v5 offset:10272
    ds_read_b64_tr_b16 v[86:87], v6 offset:10272
    ds_read_b64_tr_b16 v[88:89], v5 offset:10304
    ds_read_b64_tr_b16 v[90:91], v6 offset:10304
    ds_read_b64_tr_b16 v[92:93], v5 offset:10336
    ds_read_b64_tr_b16 v[94:95], v6 offset:10336
    ds_read_b64_tr_b16 v[96:97], v5 offset:10368
    ds_read_b64_tr_b16 v[98:99], v6 offset:10368
    ds_read_b64_tr_b16 v[100:101], v5 offset:15360
    ds_read_b64_tr_b16 v[102:103], v6 offset:15360
    ds_read_b64_tr_b16 v[104:105], v5 offset:15392
    ds_read_b64_tr_b16 v[106:107], v6 offset:15392
    ds_read_b64_tr_b16 v[108:109], v5 offset:15424
    ds_read_b64_tr_b16 v[110:111], v6 offset:15424
    ds_read_b64_tr_b16 v[112:113], v5 offset:15456
    ds_read_b64_tr_b16 v[114:115], v6 offset:15456
    ds_read_b64_tr_b16 v[116:117], v5 offset:15488
    ds_read_b64_tr_b16 v[118:119], v6 offset:15488
    s_mul_i32 s28, s14, 163840
    s_add_u32 s28, s28, s18
    s_waitcnt lgkmcnt(0)
    s_barrier
    s_add_u32 m0, s19, 0
    s_nop 0
    buffer_load_dwordx4 v11, s[20:23], s28 offen lds
    s_add_u32 m0, s19, 1024
    s_nop 0
    buffer_load_dwordx4 v12, s[20:23], s28 offen lds
    s_add_u32 m0, s19, 2048
    s_nop 0
    buffer_load_dwordx4 v13, s[20:23], s28 offen lds
    s_add_u32 m0, s19, 3072
    s_nop 0
    buffer_load_dwordx4 v14, s[20:23], s28 offen lds
    s_add_u32 m0, s19, 4096
    s_nop 0
    buffer_load_dwordx4 v15, s[20:23], s28 offen lds
    s_add_u32 s28, s28, 40960
    s_add_u32 m0, s19, 5120
    s_nop 0
    buffer_load_dwordx4 v11, s[20:23], s28 offen lds
    s_add_u32 m0, s19, 6144
    s_nop 0
    buffer_load_dwordx4 v12, s[20:23], s28 offen lds
    s_add_u32 m0, s19, 7168
    s_nop 0
    buffer_load_dwordx4 v13, s[20:23], s28 offen lds
    s_add_u32 m0, s19, 8192
    s_nop 0
    buffer_load_dwordx4 v14, s[20:23], s28 offen lds
    s_add_u32 m0, s19, 9216
    s_nop 0
    buffer_load_dwordx4 v15, s[20:23], s28 offen lds
    s_add_u32 s28, s28, 40960
    s_add_u32 m0, s19, 10240
    s_nop 0
    buffer_load_dwordx4 v11, s[20:23], s28 offen lds
    s_add_u32 m0, s19, 11264
    s_nop 0
    buffer_load_dwordx4 v12, s[20:23], s28 offen lds
    s_add_u32 m0, s19, 12288
    s_nop 0
    buffer_load_dwordx4 v13, s[20:23], s28 offen lds
    s_add_u32 m0, s19, 13312
    s_nop 0
    buffer_load_dwordx4 v14, s[20:23], s28 offen lds
    s_add_u32 m0, s19, 14336
    s_nop 0
    buffer_load_dwordx4 v15, s[20:23], s28 offen lds
    s_add_u32 s28, s28, 40960
    s_add_u32 m0, s19, 15360
    s_nop 0
    buffer_load_dwordx4 v11, s[20:23], s28 offen lds
    s_add_u32 m0, s19, 16384
    s_nop 0
    buffer_load_dwordx4 v12, s[20:23], s28 offen lds
    s_add_u32 m0, s19, 17408
    s_nop 0
    buffer_load_dwordx4 v13, s[20:23], s28 offen lds
    s_add_u32 m0, s19, 18432
    s_nop 0
    buffer_load_dwordx4 v14, s[20:23], s28 offen lds
    s_add_u32 m0, s19, 19456
    s_nop 0
    buffer_load_dwordx4 v15, s[20:23], s28 offen lds
    s_add_u32 s28, s28, 40960
    s_mov_b32 s30, s29
    s_waitcnt vmcnt(0)
    s_barrier
    ds_read_b64_tr_b16 v[120:121], v5 offset:0
    ds_read_b64_tr_b16 v[122:123], v6 offset:0
    ds_read_b64_tr_b16 v[124:125], v5 offset:32
    ds_read_b64_tr_b16 v[126:127], v6 offset:32
    ds_read_b64_tr_b16 v[128:129], v5 offset:64
    ds_read_b64_tr_b16 v[130:131], v6 offset:64
    ds_read_b64_tr_b16 v[132:133], v5 offset:96
    ds_read_b64_tr_b16 v[134:135], v6 offset:96
    ds_read_b64_tr_b16 v[136:137], v5 offset:128
    ds_read_b64_tr_b16 v[138:139], v6 offset:128
    ds_read_b64_tr_b16 v[140:141], v5 offset:5120
    ds_read_b64_tr_b16 v[142:143], v6 offset:5120
    ds_read_b64_tr_b16 v[144:145], v5 offset:5152
    ds_read_b64_tr_b16 v[146:147], v6 offset:5152
    ds_read_b64_tr_b16 v[148:149], v5 offset:5184
    ds_read_b64_tr_b16 v[150:151], v6 offset:5184
    ds_read_b64_tr_b16 v[152:153], v5 offset:5216
    ds_read_b64_tr_b16 v[154:155], v6 offset:5216
    ds_read_b64_tr_b16 v[156:157], v5 offset:5248
    ds_read_b64_tr_b16 v[158:159], v6 offset:5248
    s_cmp_lg_u32 s14, 0
    s_cbranch_scc1 g2_wo_go
    v_and_b32 v7, 31, v1
    v_lshlrev_b32 v7, 2, v7
    v_add_u32 v7, s35, v7
    s_mov_b32 s17, 40000
g2_wo_poll:
    global_load_dword v8, v7, s[42:43] sc1
    s_waitcnt vmcnt(0)
    v_cmp_eq_u32 vcc, 1, v8
    s_nop 0
    s_and_b32 s18, vcc_lo, 255
    s_cmp_eq_u32 s18, 255
    s_cbranch_scc1 g2_wo_go
    s_sleep 2
    s_sub_u32 s17, s17, 1
    s_cmp_lg_u32 s17, 0
    s_cbranch_scc1 g2_wo_poll
g2_wo_go:
    s_barrier
    s_setprio 3
    s_add_u32 s31, s30, 16384
    buffer_load_dwordx4 v[160:163], v16, s[44:47], s31 offen offset:0 sc1
    buffer_load_dwordx4 v[164:167], v16, s[44:47], s31 offen offset:1024 sc1
    buffer_load_dwordx4 v[168:171], v16, s[44:47], s31 offen offset:2048 sc1
    buffer_load_dwordx4 v[172:175], v16, s[44:47], s31 offen offset:3072 sc1
    s_add_u32 s31, s30, 0
    buffer_load_dwordx4 v[176:179], v16, s[44:47], s31 offen offset:0 sc1
    buffer_load_dwordx4 v[180:183], v16, s[44:47], s31 offen offset:1024 sc1
    buffer_load_dwordx4 v[184:187], v16, s[44:47], s31 offen offset:2048 sc1
    buffer_load_dwordx4 v[188:191], v16, s[44:47], s31 offen offset:3072 sc1
    s_add_u32 s31, s30, 4096
    buffer_load_dwordx4 v[192:195], v16, s[44:47], s31 offen offset:0 sc1
    buffer_load_dwordx4 v[196:199], v16, s[44:47], s31 offen offset:1024 sc1
    buffer_load_dwordx4 v[200:203], v16, s[44:47], s31 offen offset:2048 sc1
    buffer_load_dwordx4 v[204:207], v16, s[44:47], s31 offen offset:3072 sc1
    s_add_u32 s31, s30, 8192
    buffer_load_dwordx4 v[208:211], v16, s[44:47], s31 offen offset:0 sc1
    buffer_load_dwordx4 v[212:215], v16, s[44:47], s31 offen offset:1024 sc1
    buffer_load_dwordx4 v[216:219], v16, s[44:47], s31 offen offset:2048 sc1
    buffer_load_dwordx4 v[220:223], v16, s[44:47], s31 offen offset:3072 sc1
    s_add_u32 s31, s30, 12288
    buffer_load_dwordx4 v[224:227], v16, s[44:47], s31 offen offset:0 sc1
    buffer_load_dwordx4 v[228:231], v16, s[44:47], s31 offen offset:1024 sc1
    buffer_load_dwordx4 v[232:235], v16, s[44:47], s31 offen offset:2048 sc1
    buffer_load_dwordx4 v[236:239], v16, s[44:47], s31 offen offset:3072 sc1
    s_waitcnt vmcnt(19)
    v_mfma_f32_16x16x32_bf16 v[20:23], v[40:43], v[160:163], v[20:23]
    v_mfma_f32_16x16x32_bf16 v[24:27], v[44:47], v[160:163], v[24:27]
    v_mfma_f32_16x16x32_bf16 v[28:31], v[48:51], v[160:163], v[28:31]
    v_mfma_f32_16x16x32_bf16 v[32:35], v[52:55], v[160:163], v[32:35]
    v_mfma_f32_16x16x32_bf16 v[36:39], v[56:59], v[160:163], v[36:39]
    s_waitcnt vmcnt(18)
    v_mfma_f32_16x16x32_bf16 v[20:23], v[60:63], v[164:167], v[20:23]
    v_mfma_f32_16x16x32_bf16 v[24:27], v[64:67], v[164:167], v[24:27]
    v_mfma_f32_16x16x32_bf16 v[28:31], v[68:71], v[164:167], v[28:31]
    v_mfma_f32_16x16x32_bf16 v[32:35], v[72:75], v[164:167], v[32:35]
    v_mfma_f32_16x16x32_bf16 v[36:39], v[76:79], v[164:167], v[36:39]
    s_waitcnt vmcnt(17)
    v_mfma_f32_16x16x32_bf16 v[20:23], v[80:83], v[168:171], v[20:23]
    v_mfma_f32_16x16x32_bf16 v[24:27], v[84:87], v[168:171], v[24:27]
    v_mfma_f32_16x16x32_bf16 v[28:31], v[88:91], v[168:171], v[28:31]
    v_mfma_f32_16x16x32_bf16 v[32:35], v[92:95], v[168:171], v[32:35]
    v_mfma_f32_16x16x32_bf16 v[36:39], v[96:99], v[168:171], v[36:39]
    s_waitcnt vmcnt(16)
    v_mfma_f32_16x16x32_bf16 v[20:23], v[100:103], v[172:175], v[20:23]
    v_mfma_f32_16x16x32_bf16 v[24:27], v[104:107], v[172:175], v[24:27]
    v_mfma_f32_16x16x32_bf16 v[28:31], v[108:111], v[172:175], v[28:31]
    v_mfma_f32_16x16x32_bf16 v[32:35], v[112:115], v[172:175], v[32:35]
    v_mfma_f32_16x16x32_bf16 v[36:39], v[116:119], v[172:175], v[36:39]
    s_waitcnt vmcnt(15) lgkmcnt(10)
    v_mfma_f32_16x16x32_bf16 v[20:23], v[120:123], v[176:179], v[20:23]
    v_mfma_f32_16x16x32_bf16 v[24:27], v[124:127], v[176:179], v[24:27]
    v_mfma_f32_16x16x32_bf16 v[28:31], v[128:131], v[176:179], v[28:31]
    v_mfma_f32_16x16x32_bf16 v[32:35], v[132:135], v[176:179], v[32:35]
    v_mfma_f32_16x16x32_bf16 v[36:39], v[136:139], v[176:179], v[36:39]
    ds_read_b64_tr_b16 v[120:121], v5 offset:10240
    ds_read_b64_tr_b16 v[122:123], v6 offset:10240
    ds_read_b64_tr_b16 v[124:125], v5 offset:10272
    ds_read_b64_tr_b16 v[126:127], v6 offset:10272
    ds_read_b64_tr_b16 v[128:129], v5 offset:10304
    ds_read_b64_tr_b16 v[130:131], v6 offset:10304
    ds_read_b64_tr_b16 v[132:133], v5 offset:10336
    ds_read_b64_tr_b16 v[134:135], v6 offset:10336
    ds_read_b64_tr_b16 v[136:137], v5 offset:10368
    ds_read_b64_tr_b16 v[138:139], v6 offset:10368
    s_waitcnt vmcnt(14) lgkmcnt(10)
    v_mfma_f32_16x16x32_bf16 v[20:23], v[140:143], v[180:183], v[20:23]
    v_mfma_f32_16x16x32_bf16 v[24:27], v[144:147], v[180:183], v[24:27]
    v_mfma_f32_16x16x32_bf16 v[28:31], v[148:151], v[180:183], v[28:31]
    v_mfma_f32_16x16x32_bf16 v[32:35], v[152:155], v[180:183], v[32:35]
    v_mfma_f32_16x16x32_bf16 v[36:39], v[156:159], v[180:183], v[36:39]
    ds_read_b64_tr_b16 v[140:141], v5 offset:15360
    ds_read_b64_tr_b16 v[142:143], v6 offset:15360
    ds_read_b64_tr_b16 v[144:145], v5 offset:15392
    ds_read_b64_tr_b16 v[146:147], v6 offset:15392
    ds_read_b64_tr_b16 v[148:149], v5 offset:15424
    ds_read_b64_tr_b16 v[150:151], v6 offset:15424
    ds_read_b64_tr_b16 v[152:153], v5 offset:15456
    ds_read_b64_tr_b16 v[154:155], v6 offset:15456
    ds_read_b64_tr_b16 v[156:157], v5 offset:15488
    ds_read_b64_tr_b16 v[158:159], v6 offset:15488
    s_waitcnt vmcnt(13) lgkmcnt(10)
    v_mfma_f32_16x16x32_bf16 v[20:23], v[120:123], v[184:187], v[20:23]
    v_mfma_f32_16x16x32_bf16 v[24:27], v[124:127], v[184:187], v[24:27]
    v_mfma_f32_16x16x32_bf16 v[28:31], v[128:131], v[184:187], v[28:31]
    v_mfma_f32_16x16x32_bf16 v[32:35], v[132:135], v[184:187], v[32:35]
    v_mfma_f32_16x16x32_bf16 v[36:39], v[136:139], v[184:187], v[36:39]
    ds_read_b64_tr_b16 v[120:121], v5 offset:20480
    ds_read_b64_tr_b16 v[122:123], v6 offset:20480
    ds_read_b64_tr_b16 v[124:125], v5 offset:20512
    ds_read_b64_tr_b16 v[126:127], v6 offset:20512
    ds_read_b64_tr_b16 v[128:129], v5 offset:20544
    ds_read_b64_tr_b16 v[130:131], v6 offset:20544
    ds_read_b64_tr_b16 v[132:133], v5 offset:20576
    ds_read_b64_tr_b16 v[134:135], v6 offset:20576
    ds_read_b64_tr_b16 v[136:137], v5 offset:20608
    ds_read_b64_tr_b16 v[138:139], v6 offset:20608
    s_waitcnt vmcnt(12) lgkmcnt(10)
    v_mfma_f32_16x16x32_bf16 v[20:23], v[140:143], v[188:191], v[20:23]
    v_mfma_f32_16x16x32_bf16 v[24:27], v[144:147], v[188:191], v[24:27]
    v_mfma_f32_16x16x32_bf16 v[28:31], v[148:151], v[188:191], v[28:31]
    v_mfma_f32_16x16x32_bf16 v[32:35], v[152:155], v[188:191], v[32:35]
    v_mfma_f32_16x16x32_bf16 v[36:39], v[156:159], v[188:191], v[36:39]
    ds_read_b64_tr_b16 v[140:141], v5 offset:25600
    ds_read_b64_tr_b16 v[142:143], v6 offset:25600
    ds_read_b64_tr_b16 v[144:145], v5 offset:25632
    ds_read_b64_tr_b16 v[146:147], v6 offset:25632
    ds_read_b64_tr_b16 v[148:149], v5 offset:25664
    ds_read_b64_tr_b16 v[150:151], v6 offset:25664
    ds_read_b64_tr_b16 v[152:153], v5 offset:25696
    ds_read_b64_tr_b16 v[154:155], v6 offset:25696
    ds_read_b64_tr_b16 v[156:157], v5 offset:25728
    ds_read_b64_tr_b16 v[158:159], v6 offset:25728
    s_waitcnt vmcnt(11) lgkmcnt(10)
    v_mfma_f32_16x16x32_bf16 v[20:23], v[120:123], v[192:195], v[20:23]
    v_mfma_f32_16x16x32_bf16 v[24:27], v[124:127], v[192:195], v[24:27]
    v_mfma_f32_16x16x32_bf16 v[28:31], v[128:131], v[192:195], v[28:31]
    v_mfma_f32_16x16x32_bf16 v[32:35], v[132:135], v[192:195], v[32:35]
    v_mfma_f32_16x16x32_bf16 v[36:39], v[136:139], v[192:195], v[36:39]
    ds_read_b64_tr_b16 v[120:121], v5 offset:30720
    ds_read_b64_tr_b16 v[122:123], v6 offset:30720
    ds_read_b64_tr_b16 v[124:125], v5 offset:30752
    ds_read_b64_tr_b16 v[126:127], v6 offset:30752
    ds_read_b64_tr_b16 v[128:129], v5 offset:30784
    ds_read_b64_tr_b16 v[130:131], v6 offset:30784
    ds_read_b64_tr_b16 v[132:133], v5 offset:30816
    ds_read_b64_tr_b16 v[134:135], v6 offset:30816
    ds_read_b64_tr_b16 v[136:137], v5 offset:30848
    ds_read_b64_tr_b16 v[138:139], v6 offset:30848
    s_waitcnt vmcnt(10) lgkmcnt(10)
    v_mfma_f32_16x16x32_bf16 v[20:23], v[140:143], v[196:199], v[20:23]
    v_mfma_f32_16x16x32_bf16 v[24:27], v[144:147], v[196:199], v[24:27]
    v_mfma_f32_16x16x32_bf16 v[28:31], v[148:151], v[196:199], v[28:31]
    v_mfma_f32_16x16x32_bf16 v[32:35], v[152:155], v[196:199], v[32:35]
    v_mfma_f32_16x16x32_bf16 v[36:39], v[156:159], v[196:199], v[36:39]
    ds_read_b64_tr_b16 v[140:141], v5 offset:35840
    ds_read_b64_tr_b16 v[142:143], v6 offset:35840
    ds_read_b64_tr_b16 v[144:145], v5 offset:35872
    ds_read_b64_tr_b16 v[146:147], v6 offset:35872
    ds_read_b64_tr_b16 v[148:149], v5 offset:35904
    ds_read_b64_tr_b16 v[150:151], v6 offset:35904
    ds_read_b64_tr_b16 v[152:153], v5 offset:35936
    ds_read_b64_tr_b16 v[154:155], v6 offset:35936
    ds_read_b64_tr_b16 v[156:157], v5 offset:35968
    ds_read_b64_tr_b16 v[158:159], v6 offset:35968
    s_waitcnt vmcnt(9) lgkmcnt(10)
    v_mfma_f32_16x16x32_bf16 v[20:23], v[120:123], v[200:203], v[20:23]
    v_mfma_f32_16x16x32_bf16 v[24:27], v[124:127], v[200:203], v[24:27]
    v_mfma_f32_16x16x32_bf16 v[28:31], v[128:131], v[200:203], v[28:31]
    v_mfma_f32_16x16x32_bf16 v[32:35], v[132:135], v[200:203], v[32:35]
    v_mfma_f32_16x16x32_bf16 v[36:39], v[136:139], v[200:203], v[36:39]
    ds_read_b64_tr_b16 v[120:121], v17 offset:0
    ds_read_b64_tr_b16 v[122:123], v18 offset:0
    ds_read_b64_tr_b16 v[124:125], v17 offset:32
    ds_read_b64_tr_b16 v[126:127], v18 offset:32
    ds_read_b64_tr_b16 v[128:129], v17 offset:64
    ds_read_b64_tr_b16 v[130:131], v18 offset:64
    ds_read_b64_tr_b16 v[132:133], v17 offset:96
    ds_read_b64_tr_b16 v[134:135], v18 offset:96
    ds_read_b64_tr_b16 v[136:137], v17 offset:128
    ds_read_b64_tr_b16 v[138:139], v18 offset:128
    s_waitcnt vmcnt(8) lgkmcnt(10)
    v_mfma_f32_16x16x32_bf16 v[20:23], v[140:143], v[204:207], v[20:23]
    v_mfma_f32_16x16x32_bf16 v[24:27], v[144:147], v[204:207], v[24:27]
    v_mfma_f32_16x16x32_bf16 v[28:31], v[148:151], v[204:207], v[28:31]
    v_mfma_f32_16x16x32_bf16 v[32:35], v[152:155], v[204:207], v[32:35]
    v_mfma_f32_16x16x32_bf16 v[36:39], v[156:159], v[204:207], v[36:39]
    ds_read_b64_tr_b16 v[140:141], v17 offset:5120
    ds_read_b64_tr_b16 v[142:143], v18 offset:5120
    ds_read_b64_tr_b16 v[144:145], v17 offset:5152
    ds_read_b64_tr_b16 v[146:147], v18 offset:5152
    ds_read_b64_tr_b16 v[148:149], v17 offset:5184
    ds_read_b64_tr_b16 v[150:151], v18 offset:5184
    ds_read_b64_tr_b16 v[152:153], v17 offset:5216
    ds_read_b64_tr_b16 v[154:155], v18 offset:5216
    ds_read_b64_tr_b16 v[156:157], v17 offset:5248
    ds_read_b64_tr_b16 v[158:159], v18 offset:5248
    s_waitcnt vmcnt(7) lgkmcnt(10)
    v_mfma_f32_16x16x32_bf16 v[20:23], v[120:123], v[208:211], v[20:23]
    v_mfma_f32_16x16x32_bf16 v[24:27], v[124:127], v[208:211], v[24:27]
    v_mfma_f32_16x16x32_bf16 v[28:31], v[128:131], v[208:211], v[28:31]
    v_mfma_f32_16x16x32_bf16 v[32:35], v[132:135], v[208:211], v[32:35]
    v_mfma_f32_16x16x32_bf16 v[36:39], v[136:139], v[208:211], v[36:39]
    ds_read_b64_tr_b16 v[120:121], v17 offset:10240
    ds_read_b64_tr_b16 v[122:123], v18 offset:10240
    ds_read_b64_tr_b16 v[124:125], v17 offset:10272
    ds_read_b64_tr_b16 v[126:127], v18 offset:10272
    ds_read_b64_tr_b16 v[128:129], v17 offset:10304
    ds_read_b64_tr_b16 v[130:131], v18 offset:10304
    ds_read_b64_tr_b16 v[132:133], v17 offset:10336
    ds_read_b64_tr_b16 v[134:135], v18 offset:10336
    ds_read_b64_tr_b16 v[136:137], v17 offset:10368
    ds_read_b64_tr_b16 v[138:139], v18 offset:10368
    s_waitcnt vmcnt(6) lgkmcnt(10)
    v_mfma_f32_16x16x32_bf16 v[20:23], v[140:143], v[212:215], v[20:23]
    v_mfma_f32_16x16x32_bf16 v[24:27], v[144:147], v[212:215], v[24:27]
    v_mfma_f32_16x16x32_bf16 v[28:31], v[148:151], v[212:215], v[28:31]
    v_mfma_f32_16x16x32_bf16 v[32:35], v[152:155], v[212:215], v[32:35]
    v_mfma_f32_16x16x32_bf16 v[36:39], v[156:159], v[212:215], v[36:39]
    ds_read_b64_tr_b16 v[140:141], v17 offset:15360
    ds_read_b64_tr_b16 v[142:143], v18 offset:15360
    ds_read_b64_tr_b16 v[144:145], v17 offset:15392
    ds_read_b64_tr_b16 v[146:147], v18 offset:15392
    ds_read_b64_tr_b16 v[148:149], v17 offset:15424
    ds_read_b64_tr_b16 v[150:151], v18 offset:15424
    ds_read_b64_tr_b16 v[152:153], v17 offset:15456
    ds_read_b64_tr_b16 v[154:155], v18 offset:15456
    ds_read_b64_tr_b16 v[156:157], v17 offset:15488
    ds_read_b64_tr_b16 v[158:159], v18 offset:15488
    s_waitcnt vmcnt(5) lgkmcnt(10)
    v_mfma_f32_16x16x32_bf16 v[20:23], v[120:123], v[216:219], v[20:23]
    v_mfma_f32_16x16x32_bf16 v[24:27], v[124:127], v[216:219], v[24:27]
    v_mfma_f32_16x16x32_bf16 v[28:31], v[128:131], v[216:219], v[28:31]
    v_mfma_f32_16x16x32_bf16 v[32:35], v[132:135], v[216:219], v[32:35]
    v_mfma_f32_16x16x32_bf16 v[36:39], v[136:139], v[216:219], v[36:39]
    ds_read_b64_tr_b16 v[120:121], v17 offset:20480
    ds_read_b64_tr_b16 v[122:123], v18 offset:20480
    ds_read_b64_tr_b16 v[124:125], v17 offset:20512
    ds_read_b64_tr_b16 v[126:127], v18 offset:20512
    ds_read_b64_tr_b16 v[128:129], v17 offset:20544
    ds_read_b64_tr_b16 v[130:131], v18 offset:20544
    ds_read_b64_tr_b16 v[132:133], v17 offset:20576
    ds_read_b64_tr_b16 v[134:135], v18 offset:20576
    ds_read_b64_tr_b16 v[136:137], v17 offset:20608
    ds_read_b64_tr_b16 v[138:139], v18 offset:20608
    s_waitcnt vmcnt(4) lgkmcnt(10)
    v_mfma_f32_16x16x32_bf16 v[20:23], v[140:143], v[220:223], v[20:23]
    v_mfma_f32_16x16x32_bf16 v[24:27], v[144:147], v[220:223], v[24:27]
    v_mfma_f32_16x16x32_bf16 v[28:31], v[148:151], v[220:223], v[28:31]
    v_mfma_f32_16x16x32_bf16 v[32:35], v[152:155], v[220:223], v[32:35]
    v_mfma_f32_16x16x32_bf16 v[36:39], v[156:159], v[220:223], v[36:39]
    ds_read_b64_tr_b16 v[140:141], v17 offset:25600
    ds_read_b64_tr_b16 v[142:143], v18 offset:25600
    ds_read_b64_tr_b16 v[144:145], v17 offset:25632
    ds_read_b64_tr_b16 v[146:147], v18 offset:25632
    ds_read_b64_tr_b16 v[148:149], v17 offset:25664
    ds_read_b64_tr_b16 v[150:151], v18 offset:25664
    ds_read_b64_tr_b16 v[152:153], v17 offset:25696
    ds_read_b64_tr_b16 v[154:155], v18 offset:25696
    ds_read_b64_tr_b16 v[156:157], v17 offset:25728
    ds_read_b64_tr_b16 v[158:159], v18 offset:25728
    s_waitcnt vmcnt(3) lgkmcnt(10)
    v_mfma_f32_16x16x32_bf16 v[20:23], v[120:123], v[224:227], v[20:23]
    v_mfma_f32_16x16x32_bf16 v[24:27], v[124:127], v[224:227], v[24:27]
    v_mfma_f32_16x16x32_bf16 v[28:31], v[128:131], v[224:227], v[28:31]
    v_mfma_f32_16x16x32_bf16 v[32:35], v[132:135], v[224:227], v[32:35]
    v_mfma_f32_16x16x32_bf16 v[36:39], v[136:139], v[224:227], v[36:39]
    ds_read_b64_tr_b16 v[120:121], v17 offset:30720
    ds_read_b64_tr_b16 v[122:123], v18 offset:30720
    ds_read_b64_tr_b16 v[124:125], v17 offset:30752
    ds_read_b64_tr_b16 v[126:127], v18 offset:30752
    ds_read_b64_tr_b16 v[128:129], v17 offset:30784
    ds_read_b64_tr_b16 v[130:131], v18 offset:30784
    ds_read_b64_tr_b16 v[132:133], v17 offset:30816
    ds_read_b64_tr_b16 v[134:135], v18 offset:30816
    ds_read_b64_tr_b16 v[136:137], v17 offset:30848
    ds_read_b64_tr_b16 v[138:139], v18 offset:30848
    s_waitcnt vmcnt(2) lgkmcnt(10)
    v_mfma_f32_16x16x32_bf16 v[20:23], v[140:143], v[228:231], v[20:23]
    v_mfma_f32_16x16x32_bf16 v[24:27], v[144:147], v[228:231], v[24:27]
    v_mfma_f32_16x16x32_bf16 v[28:31], v[148:151], v[228:231], v[28:31]
    v_mfma_f32_16x16x32_bf16 v[32:35], v[152:155], v[228:231], v[32:35]
    v_mfma_f32_16x16x32_bf16 v[36:39], v[156:159], v[228:231], v[36:39]
    ds_read_b64_tr_b16 v[140:141], v17 offset:35840
    ds_read_b64_tr_b16 v[142:143], v18 offset:35840
    ds_read_b64_tr_b16 v[144:145], v17 offset:35872
    ds_read_b64_tr_b16 v[146:147], v18 offset:35872
    ds_read_b64_tr_b16 v[148:149], v17 offset:35904
    ds_read_b64_tr_b16 v[150:151], v18 offset:35904
    ds_read_b64_tr_b16 v[152:153], v17 offset:35936
    ds_read_b64_tr_b16 v[154:155], v18 offset:35936
    ds_read_b64_tr_b16 v[156:157], v17 offset:35968
    ds_read_b64_tr_b16 v[158:159], v18 offset:35968
    s_waitcnt vmcnt(1) lgkmcnt(10)
    v_mfma_f32_16x16x32_bf16 v[20:23], v[120:123], v[232:235], v[20:23]
    v_mfma_f32_16x16x32_bf16 v[24:27], v[124:127], v[232:235], v[24:27]
    v_mfma_f32_16x16x32_bf16 v[28:31], v[128:131], v[232:235], v[28:31]
    v_mfma_f32_16x16x32_bf16 v[32:35], v[132:135], v[232:235], v[32:35]
    v_mfma_f32_16x16x32_bf16 v[36:39], v[136:139], v[232:235], v[36:39]
    s_waitcnt vmcnt(0) lgkmcnt(0)
    v_mfma_f32_16x16x32_bf16 v[20:23], v[140:143], v[236:239], v[20:23]
    v_mfma_f32_16x16x32_bf16 v[24:27], v[144:147], v[236:239], v[24:27]
    v_mfma_f32_16x16x32_bf16 v[28:31], v[148:151], v[236:239], v[28:31]
    v_mfma_f32_16x16x32_bf16 v[32:35], v[152:155], v[236:239], v[32:35]
    v_mfma_f32_16x16x32_bf16 v[36:39], v[156:159], v[236:239], v[36:39]
    s_nop 3
    v_cvt_pk_bf16_f32 v40, v20, v21
    v_cvt_pk_bf16_f32 v41, v22, v23
    global_store_dwordx2 v10, v[40:41], s[38:39] offset:0
    v_cvt_pk_bf16_f32 v42, v24, v25
    v_cvt_pk_bf16_f32 v43, v26, v27
    global_store_dwordx2 v10, v[42:43], s[38:39] offset:32
    v_cvt_pk_bf16_f32 v44, v28, v29
    v_cvt_pk_bf16_f32 v45, v30, v31
    global_store_dwordx2 v10, v[44:45], s[38:39] offset:64
    v_cvt_pk_bf16_f32 v46, v32, v33
    v_cvt_pk_bf16_f32 v47, v34, v35
    global_store_dwordx2 v10, v[46:47], s[38:39] offset:96
    v_cvt_pk_bf16_f32 v48, v36, v37
    v_cvt_pk_bf16_f32 v49, v38, v39
    global_store_dwordx2 v10, v[48:49], s[38:39] offset:128
k2_exit:
    s_endpgm

.section .rodata,"a"
.p2align 6
.amdhsa_kernel k2_kernel
  .amdhsa_next_free_vgpr 256
  .amdhsa_next_free_sgpr 100
  .amdhsa_accum_offset 256
  .amdhsa_group_segment_fixed_size 0
  .amdhsa_kernarg_size 96
  .amdhsa_user_sgpr_count 2
  .amdhsa_user_sgpr_kernarg_segment_ptr 1
  .amdhsa_system_sgpr_workgroup_id_x 1
.end_amdhsa_kernel
```
